```python
import torch

def _softmax(x, axis=-1):
    return torch.softmax(x, dim=axis)
def _gelu(x):
    return torch.nn.functional.gelu(x, approximate="tanh")
def _silu(x):
    return torch.nn.functional.silu(x)
def _sigmoid(x):
    return torch.sigmoid(x)
def _layernorm(x, axis=-1, eps=1e-5):
    m = x.mean(dim=axis, keepdim=True)
    v = x.var(dim=axis, keepdim=True, unbiased=False)
    return (x - m) / torch.sqrt(v + eps)
def _scatter_add(tgt, idx, src, axis=0):
    return tgt.clone().index_add_(axis, idx, src)
def _segment_sum(src, seg, n):
    out = torch.zeros((n,) + src.shape[1:], dtype=src.dtype)
    return out.index_add_(0, seg, src)
def _pad(x, pw):
    flat = tuple(v for pair in reversed(pw) for v in pair)
    return torch.nn.functional.pad(x, flat)

kernel_name = 'concat_heads__gqa_block_cached__gqa_block_cached__near_ridge'

def setup_inputs():

    _w = (lambda a: (lambda t: t.to(torch.bfloat16) if t.is_floating_point() else t)(torch.as_tensor(a)))
    def _A_setup():
        B, Sq, D = 16, 48, 448
        Hq, Hkv, Sk, Dh = 16, 8, 48, 256
        assert Hq % Hkv == 0, (Hq, Hkv)
        return {
            "x": _w((lambda *s: torch.randn(*s, dtype=torch.bfloat16) * 0.8)(B, Sq, D)),
            "k_cache": _w((lambda *s: torch.randn(*s, dtype=torch.bfloat16) * 0.8)(B, Hkv, Sk, Dh)),
            "v_cache": _w((lambda *s: torch.randn(*s, dtype=torch.bfloat16) * 0.05)(B, Hkv, Sk, Dh)),
            "wq": _w((lambda *s: torch.randn(*s, dtype=torch.bfloat16) * 0.8)(D, Hq * Dh) * (D ** -0.5)),
            "wo": _w((lambda *s: torch.randn(*s, dtype=torch.bfloat16) * 0.05)(Hq * Dh, D) * ((Hq * Dh) ** -0.5)),
        }
    _A_in = _A_setup()

    def _B_setup():
        B, Sq, D = 16, 48, 448
        Hq, Hkv, Sk, Dh = 16, 8, 48, 256
        assert Hq % Hkv == 0, (Hq, Hkv)
        return {
            "x": _w((lambda *s: torch.randn(*s, dtype=torch.bfloat16) * 0.8)(B, Sq, D)),
            "k_cache": _w((lambda *s: torch.randn(*s, dtype=torch.bfloat16) * 0.8)(B, Hkv, Sk, Dh)),
            "v_cache": _w((lambda *s: torch.randn(*s, dtype=torch.bfloat16) * 0.05)(B, Hkv, Sk, Dh)),
            "wq": _w((lambda *s: torch.randn(*s, dtype=torch.bfloat16) * 0.8)(D, Hq * Dh) * (D ** -0.5)),
            "wo": _w((lambda *s: torch.randn(*s, dtype=torch.bfloat16) * 0.05)(Hq * Dh, D) * ((Hq * Dh) ** -0.5)),
        }
    _B_in = _B_setup()

    return {
        "A_x": _A_in["x"],
        "A_k_cache": _A_in["k_cache"],
        "A_v_cache": _A_in["v_cache"],
        "A_wq": _A_in["wq"],
        "A_wo": _A_in["wo"],
        "B_x": _B_in["x"],
        "B_k_cache": _B_in["k_cache"],
        "B_v_cache": _B_in["v_cache"],
        "B_wq": _B_in["wq"],
        "B_wo": _B_in["wo"],
    }

def reference(A_x, A_k_cache, A_v_cache, A_wq, A_wo, B_x, B_k_cache, B_v_cache, B_wq, B_wo):
    def _A_ref(x, k_cache, v_cache, wq, wo):
        B, Sq, D = x.shape
        Hq, Dh = 16, 256
        Hkv = k_cache.shape[1]
        rep = Hq // Hkv
        q = (lambda x, *d: x.permute(*d))((x @ wq).reshape(B, Sq, Hq, Dh), 0, 2, 1, 3)
        k = (lambda x, n, axis: torch.repeat_interleave(x, n, dim=axis))(k_cache, rep, axis=1)
        v = (lambda x, n, axis: torch.repeat_interleave(x, n, dim=axis))(v_cache, rep, axis=1)
        scores = torch.einsum("bhqd,bhkd->bhqk", q, k) * (Dh ** -0.5)
        p = _softmax(scores, axis=-1)
        o = torch.einsum("bhqk,bhkd->bhqd", p, v)
        return (lambda x, *d: x.permute(*d))(o, 0, 2, 1, 3).reshape(B, Sq, Hq * Dh) @ wo

    def _B_ref(x, k_cache, v_cache, wq, wo):
        B, Sq, D = x.shape
        Hq, Dh = 16, 256
        Hkv = k_cache.shape[1]
        rep = Hq // Hkv
        q = (lambda x, *d: x.permute(*d))((x @ wq).reshape(B, Sq, Hq, Dh), 0, 2, 1, 3)
        k = (lambda x, n, axis: torch.repeat_interleave(x, n, dim=axis))(k_cache, rep, axis=1)
        v = (lambda x, n, axis: torch.repeat_interleave(x, n, dim=axis))(v_cache, rep, axis=1)
        scores = torch.einsum("bhqd,bhkd->bhqk", q, k) * (Dh ** -0.5)
        p = _softmax(scores, axis=-1)
        o = torch.einsum("bhqk,bhkd->bhqd", p, v)
        return (lambda x, *d: x.permute(*d))(o, 0, 2, 1, 3).reshape(B, Sq, Hq * Dh) @ wo

    a = _A_ref(A_x, A_k_cache, A_v_cache, A_wq, A_wo)
    b = _B_ref(B_x, B_k_cache, B_v_cache, B_wq, B_wo)
    return torch.concatenate([a, b], axis=-1)
```

```asm
; @launch kernel=k1_kernel grid=(256,1,1) block=(512,1,1) lds=158720
; @launch kernel=k2_kernel grid=(256,1,1) block=(448,1,1) lds=122880
; @launch kernel=k3_kernel grid=(336,1,1) block=(512,1,1) lds=0
.amdgcn_target "amdgcn-amd-amdhsa--gfx950"
.text
.globl k1_kernel
.p2align 8
.type k1_kernel,@function
k1_kernel:
    s_cmp_ge_u32 s2, 256
    s_cbranch_scc1 k1_end
    s_and_b32 s3, s2, 7
    s_lshr_b32 s4, s2, 3
    s_lshl_b32 s5, s3, 2
    s_lshr_b32 s6, s4, 3
    s_add_u32 s5, s5, s6
    s_lshr_b32 s6, s5, 4
    s_and_b32 s7, s5, 15
    s_and_b32 s8, s4, 7
    s_mul_i32 s9, s6, 40
    s_add_u32 s10, s0, s9
    s_addc_u32 s11, s1, 0
    s_load_dwordx8 s[12:19], s[10:11], 0
    s_load_dwordx2 s[20:21], s[0:1], 96
    v_and_b32 v1, 63, v0
    v_lshrrev_b32 v2, 6, v0
    s_nop 0
    v_readfirstlane_b32 s24, v2
    v_lshlrev_b32 v10, 4, v1
    v_mul_u32_u24 v3, 896, v2
    v_add_u32 v10, v10, v3
    v_lshrrev_b32 v3, 5, v1
    v_lshl_add_u32 v3, v2, 1, v3
    v_bfe_u32 v4, v3, 2, 2
    v_and_b32 v5, 3, v3
    v_lshl_add_u32 v4, v4, 3, v5
    v_lshlrev_b32 v4, 13, v4
    v_bfe_u32 v5, v1, 1, 4
    v_and_b32 v6, 7, v3
    v_xor_b32 v5, v5, v6
    v_and_b32 v6, 1, v1
    v_lshl_add_u32 v5, v5, 1, v6
    v_lshl_add_u32 v12, v5, 4, v4
    v_add_u32 v13, 32768, v12
    v_lshrrev_b32 v3, 5, v0
    v_and_b32 v4, 31, v0
    v_lshlrev_b32 v4, 4, v4
    v_lshlrev_b32 v16, 4, v0
    v_mul_u32_u24 v5, 544, v3
    v_add_u32 v17, v5, v4
    v_add_u32 v17, 52224, v17
    s_mul_i32 s30, s24, 928
    s_lshl_b32 s31, s24, 10
    s_add_u32 s31, s31, 89088
    s_add_u32 s34, s31, 8192
    s_waitcnt lgkmcnt(0)
    s_mul_i32 s9, s8, 86016
    s_add_u32 s12, s12, s9
    s_addc_u32 s13, s13, 0
    s_lshl_b32 s9, s8, 4
    s_lshr_b32 s25, s7, 1
    s_add_u32 s9, s9, s25
    s_mul_i32 s9, s9, 24576
    s_add_u32 s14, s14, s9
    s_addc_u32 s15, s15, 0
    s_add_u32 s16, s16, s9
    s_addc_u32 s17, s17, 0
    s_add_u32 s26, s16, 196608
    s_addc_u32 s27, s17, 0
    s_add_u32 s32, s14, 196608
    s_addc_u32 s33, s15, 0
    s_lshl_b32 s9, s7, 9
    s_add_u32 s22, s18, s9
    s_addc_u32 s23, s19, 0
    s_add_u32 m0, s31, 0
    s_nop 0
    global_load_lds_dwordx4 v12, s[22:23]
    s_add_u32 m0, s34, 0
    s_nop 0
    global_load_lds_dwordx4 v13, s[22:23]
    s_add_u32 s22, s22, 262144
    s_addc_u32 s23, s23, 0
    s_add_u32 m0, s31, 16384
    s_nop 0
    global_load_lds_dwordx4 v12, s[22:23]
    s_add_u32 m0, s34, 16384
    s_nop 0
    global_load_lds_dwordx4 v13, s[22:23]
    s_add_u32 s22, s22, 262144
    s_addc_u32 s23, s23, 0
    s_mov_b64 s[36:37], exec
    s_mov_b32 exec_hi, 0x00ffffff
    s_add_u32 m0, s30, 0
    s_nop 0
    global_load_lds_dwordx4 v10, s[12:13]
    s_add_u32 s12, s12, 7168
    s_addc_u32 s13, s13, 0
    s_add_u32 m0, s30, 7424
    s_nop 0
    global_load_lds_dwordx4 v10, s[12:13]
    s_add_u32 s12, s12, 7168
    s_addc_u32 s13, s13, 0
    s_add_u32 m0, s30, 14848
    s_nop 0
    global_load_lds_dwordx4 v10, s[12:13]
    s_add_u32 s12, s12, 7168
    s_addc_u32 s13, s13, 0
    s_add_u32 m0, s30, 22272
    s_nop 0
    global_load_lds_dwordx4 v10, s[12:13]
    s_add_u32 s12, s12, 7168
    s_addc_u32 s13, s13, 0
    s_add_u32 m0, s30, 29696
    s_nop 0
    global_load_lds_dwordx4 v10, s[12:13]
    s_add_u32 s12, s12, 7168
    s_addc_u32 s13, s13, 0
    s_add_u32 m0, s30, 37120
    s_nop 0
    global_load_lds_dwordx4 v10, s[12:13]
    s_add_u32 s12, s12, 7168
    s_addc_u32 s13, s13, 0
    s_add_u32 m0, s30, 44544
    s_nop 0
    global_load_lds_dwordx4 v10, s[12:13]
    s_add_u32 s12, s12, 7168
    s_addc_u32 s13, s13, 0
    s_add_u32 m0, s30, 51968
    s_nop 0
    global_load_lds_dwordx4 v10, s[12:13]
    s_add_u32 s12, s12, 7168
    s_addc_u32 s13, s13, 0
    s_add_u32 m0, s30, 59392
    s_nop 0
    global_load_lds_dwordx4 v10, s[12:13]
    s_add_u32 s12, s12, 7168
    s_addc_u32 s13, s13, 0
    s_add_u32 m0, s30, 66816
    s_nop 0
    global_load_lds_dwordx4 v10, s[12:13]
    s_add_u32 s12, s12, 7168
    s_addc_u32 s13, s13, 0
    s_add_u32 m0, s30, 74240
    s_nop 0
    global_load_lds_dwordx4 v10, s[12:13]
    s_add_u32 s12, s12, 7168
    s_addc_u32 s13, s13, 0
    s_add_u32 m0, s30, 81664
    s_nop 0
    global_load_lds_dwordx4 v10, s[12:13]
    s_mov_b64 exec, s[36:37]
    s_add_u32 m0, s31, 32768
    s_nop 0
    global_load_lds_dwordx4 v12, s[22:23]
    s_add_u32 m0, s34, 32768
    s_nop 0
    global_load_lds_dwordx4 v13, s[22:23]
    s_add_u32 s22, s22, 262144
    s_addc_u32 s23, s23, 0
    s_add_u32 m0, s31, 49152
    s_nop 0
    global_load_lds_dwordx4 v12, s[22:23]
    s_add_u32 m0, s34, 49152
    s_nop 0
    global_load_lds_dwordx4 v13, s[22:23]
    s_add_u32 s22, s22, 262144
    s_addc_u32 s23, s23, 0
    v_and_b32 v3, 15, v1
    v_lshrrev_b32 v4, 4, v1
    s_lshr_b32 s25, s24, 2
    s_and_b32 s28, s24, 3
    s_mul_i32 s29, s25, 44544
    v_mul_u32_u24 v5, 928, v3
    v_lshlrev_b32 v6, 4, v4
    v_add3_u32 v14, v5, v6, s29
    v_lshrrev_b32 v5, 2, v3
    v_lshl_add_u32 v5, v4, 2, v5
    v_and_b32 v6, 3, v1
    v_lshlrev_b32 v6, 3, v6
    v_mul_u32_u24 v7, 544, v5
    v_add_u32 v19, v7, v6
    v_lshlrev_b32 v7, 9, v5
    v_add_u32 v7, v7, v6
    v_add_u32 v7, 89088, v7
    v_and_b32 v8, 7, v5
    s_lshl_b32 s29, s28, 2
    s_add_u32 s35, s29, 0
    v_xor_b32 v9, s35, v8
    v_lshl_add_u32 v124, v9, 5, v7
    s_add_u32 s35, s29, 1
    v_xor_b32 v9, s35, v8
    v_lshl_add_u32 v125, v9, 5, v7
    s_add_u32 s35, s29, 2
    v_xor_b32 v9, s35, v8
    v_lshl_add_u32 v126, v9, 5, v7
    s_add_u32 s35, s29, 3
    v_xor_b32 v9, s35, v8
    v_lshl_add_u32 v127, v9, 5, v7
    v_mov_b32 v20, 0
    v_mov_b32 v21, 0
    v_mov_b32 v22, 0
    v_mov_b32 v23, 0
    v_mov_b32 v24, 0
    v_mov_b32 v25, 0
    v_mov_b32 v26, 0
    v_mov_b32 v27, 0
    v_mov_b32 v28, 0
    v_mov_b32 v29, 0
    v_mov_b32 v30, 0
    v_mov_b32 v31, 0
    v_mov_b32 v32, 0
    v_mov_b32 v33, 0
    v_mov_b32 v34, 0
    v_mov_b32 v35, 0
    v_mov_b32 v36, 0
    v_mov_b32 v37, 0
    v_mov_b32 v38, 0
    v_mov_b32 v39, 0
    v_mov_b32 v40, 0
    v_mov_b32 v41, 0
    v_mov_b32 v42, 0
    v_mov_b32 v43, 0
    v_mov_b32 v44, 0
    v_mov_b32 v45, 0
    v_mov_b32 v46, 0
    v_mov_b32 v47, 0
    v_mov_b32 v48, 0
    v_mov_b32 v49, 0
    v_mov_b32 v50, 0
    v_mov_b32 v51, 0
    v_mov_b32 v52, 0
    v_mov_b32 v53, 0
    v_mov_b32 v54, 0
    v_mov_b32 v55, 0
    v_mov_b32 v56, 0
    v_mov_b32 v57, 0
    v_mov_b32 v58, 0
    v_mov_b32 v59, 0
    v_mov_b32 v60, 0
    v_mov_b32 v61, 0
    v_mov_b32 v62, 0
    v_mov_b32 v63, 0
    v_mov_b32 v64, 0
    v_mov_b32 v65, 0
    v_mov_b32 v66, 0
    v_mov_b32 v67, 0
    s_waitcnt vmcnt(4)
    s_barrier
    ds_read_b128 v[100:103], v14 offset:0
    ds_read_b128 v[104:107], v14 offset:14848
    ds_read_b128 v[108:111], v14 offset:29696
    ds_read_b64_tr_b16 v[68:69], v124 offset:0
    ds_read_b64_tr_b16 v[70:71], v124 offset:8192
    ds_read_b64_tr_b16 v[72:73], v125 offset:0
    ds_read_b64_tr_b16 v[74:75], v125 offset:8192
    ds_read_b64_tr_b16 v[76:77], v126 offset:0
    ds_read_b64_tr_b16 v[78:79], v126 offset:8192
    ds_read_b64_tr_b16 v[80:81], v127 offset:0
    ds_read_b64_tr_b16 v[82:83], v127 offset:8192
    s_waitcnt lgkmcnt(0)
    s_barrier
    s_add_u32 m0, s31, 0
    s_nop 0
    global_load_lds_dwordx4 v12, s[22:23]
    s_add_u32 m0, s34, 0
    s_nop 0
    global_load_lds_dwordx4 v13, s[22:23]
    s_add_u32 s22, s22, 262144
    s_addc_u32 s23, s23, 0
    v_mfma_f32_16x16x32_bf16 v[20:23], v[68:71], v[100:103], v[20:23]
    ds_read_b128 v[112:115], v14 offset:64
    v_mfma_f32_16x16x32_bf16 v[24:27], v[68:71], v[104:107], v[24:27]
    ds_read_b128 v[116:119], v14 offset:14912
    v_mfma_f32_16x16x32_bf16 v[28:31], v[68:71], v[108:111], v[28:31]
    ds_read_b128 v[120:123], v14 offset:29760
    v_mfma_f32_16x16x32_bf16 v[32:35], v[72:75], v[100:103], v[32:35]
    ds_read_b64_tr_b16 v[84:85], v124 offset:16384
    v_mfma_f32_16x16x32_bf16 v[36:39], v[72:75], v[104:107], v[36:39]
    ds_read_b64_tr_b16 v[86:87], v124 offset:24576
    v_mfma_f32_16x16x32_bf16 v[40:43], v[72:75], v[108:111], v[40:43]
    ds_read_b64_tr_b16 v[88:89], v125 offset:16384
    v_mfma_f32_16x16x32_bf16 v[44:47], v[76:79], v[100:103], v[44:47]
    ds_read_b64_tr_b16 v[90:91], v125 offset:24576
    v_mfma_f32_16x16x32_bf16 v[48:51], v[76:79], v[104:107], v[48:51]
    ds_read_b64_tr_b16 v[92:93], v126 offset:16384
    v_mfma_f32_16x16x32_bf16 v[52:55], v[76:79], v[108:111], v[52:55]
    ds_read_b64_tr_b16 v[94:95], v126 offset:24576
    v_mfma_f32_16x16x32_bf16 v[56:59], v[80:83], v[100:103], v[56:59]
    ds_read_b64_tr_b16 v[96:97], v127 offset:16384
    v_mfma_f32_16x16x32_bf16 v[60:63], v[80:83], v[104:107], v[60:63]
    ds_read_b64_tr_b16 v[98:99], v127 offset:24576
    v_mfma_f32_16x16x32_bf16 v[64:67], v[80:83], v[108:111], v[64:67]
    s_waitcnt vmcnt(4) lgkmcnt(0)
    s_barrier
    s_add_u32 m0, s31, 16384
    s_nop 0
    global_load_lds_dwordx4 v12, s[22:23]
    s_add_u32 m0, s34, 16384
    s_nop 0
    global_load_lds_dwordx4 v13, s[22:23]
    s_add_u32 s22, s22, 262144
    s_addc_u32 s23, s23, 0
    v_mfma_f32_16x16x32_bf16 v[20:23], v[84:87], v[112:115], v[20:23]
    ds_read_b128 v[100:103], v14 offset:128
    v_mfma_f32_16x16x32_bf16 v[24:27], v[84:87], v[116:119], v[24:27]
    ds_read_b128 v[104:107], v14 offset:14976
    v_mfma_f32_16x16x32_bf16 v[28:31], v[84:87], v[120:123], v[28:31]
    ds_read_b128 v[108:111], v14 offset:29824
    v_mfma_f32_16x16x32_bf16 v[32:35], v[88:91], v[112:115], v[32:35]
    ds_read_b64_tr_b16 v[68:69], v124 offset:32768
    v_mfma_f32_16x16x32_bf16 v[36:39], v[88:91], v[116:119], v[36:39]
    ds_read_b64_tr_b16 v[70:71], v124 offset:40960
    v_mfma_f32_16x16x32_bf16 v[40:43], v[88:91], v[120:123], v[40:43]
    ds_read_b64_tr_b16 v[72:73], v125 offset:32768
    v_mfma_f32_16x16x32_bf16 v[44:47], v[92:95], v[112:115], v[44:47]
    ds_read_b64_tr_b16 v[74:75], v125 offset:40960
    v_mfma_f32_16x16x32_bf16 v[48:51], v[92:95], v[116:119], v[48:51]
    ds_read_b64_tr_b16 v[76:77], v126 offset:32768
    v_mfma_f32_16x16x32_bf16 v[52:55], v[92:95], v[120:123], v[52:55]
    ds_read_b64_tr_b16 v[78:79], v126 offset:40960
    v_mfma_f32_16x16x32_bf16 v[56:59], v[96:99], v[112:115], v[56:59]
    ds_read_b64_tr_b16 v[80:81], v127 offset:32768
    v_mfma_f32_16x16x32_bf16 v[60:63], v[96:99], v[116:119], v[60:63]
    ds_read_b64_tr_b16 v[82:83], v127 offset:40960
    v_mfma_f32_16x16x32_bf16 v[64:67], v[96:99], v[120:123], v[64:67]
    s_waitcnt vmcnt(4) lgkmcnt(0)
    s_barrier
    s_add_u32 m0, s31, 32768
    s_nop 0
    global_load_lds_dwordx4 v12, s[22:23]
    s_add_u32 m0, s34, 32768
    s_nop 0
    global_load_lds_dwordx4 v13, s[22:23]
    s_add_u32 s22, s22, 262144
    s_addc_u32 s23, s23, 0
    v_mfma_f32_16x16x32_bf16 v[20:23], v[68:71], v[100:103], v[20:23]
    ds_read_b128 v[112:115], v14 offset:192
    v_mfma_f32_16x16x32_bf16 v[24:27], v[68:71], v[104:107], v[24:27]
    ds_read_b128 v[116:119], v14 offset:15040
    v_mfma_f32_16x16x32_bf16 v[28:31], v[68:71], v[108:111], v[28:31]
    ds_read_b128 v[120:123], v14 offset:29888
    v_mfma_f32_16x16x32_bf16 v[32:35], v[72:75], v[100:103], v[32:35]
    ds_read_b64_tr_b16 v[84:85], v124 offset:49152
    v_mfma_f32_16x16x32_bf16 v[36:39], v[72:75], v[104:107], v[36:39]
    ds_read_b64_tr_b16 v[86:87], v124 offset:57344
    v_mfma_f32_16x16x32_bf16 v[40:43], v[72:75], v[108:111], v[40:43]
    ds_read_b64_tr_b16 v[88:89], v125 offset:49152
    v_mfma_f32_16x16x32_bf16 v[44:47], v[76:79], v[100:103], v[44:47]
    ds_read_b64_tr_b16 v[90:91], v125 offset:57344
    v_mfma_f32_16x16x32_bf16 v[48:51], v[76:79], v[104:107], v[48:51]
    ds_read_b64_tr_b16 v[92:93], v126 offset:49152
    v_mfma_f32_16x16x32_bf16 v[52:55], v[76:79], v[108:111], v[52:55]
    ds_read_b64_tr_b16 v[94:95], v126 offset:57344
    v_mfma_f32_16x16x32_bf16 v[56:59], v[80:83], v[100:103], v[56:59]
    ds_read_b64_tr_b16 v[96:97], v127 offset:49152
    v_mfma_f32_16x16x32_bf16 v[60:63], v[80:83], v[104:107], v[60:63]
    ds_read_b64_tr_b16 v[98:99], v127 offset:57344
    v_mfma_f32_16x16x32_bf16 v[64:67], v[80:83], v[108:111], v[64:67]
    s_waitcnt vmcnt(4) lgkmcnt(0)
    s_barrier
    s_add_u32 m0, s31, 49152
    s_nop 0
    global_load_lds_dwordx4 v12, s[22:23]
    s_add_u32 m0, s34, 49152
    s_nop 0
    global_load_lds_dwordx4 v13, s[22:23]
    s_add_u32 s22, s22, 262144
    s_addc_u32 s23, s23, 0
    v_mfma_f32_16x16x32_bf16 v[20:23], v[84:87], v[112:115], v[20:23]
    ds_read_b128 v[100:103], v14 offset:256
    v_mfma_f32_16x16x32_bf16 v[24:27], v[84:87], v[116:119], v[24:27]
    ds_read_b128 v[104:107], v14 offset:15104
    v_mfma_f32_16x16x32_bf16 v[28:31], v[84:87], v[120:123], v[28:31]
    ds_read_b128 v[108:111], v14 offset:29952
    v_mfma_f32_16x16x32_bf16 v[32:35], v[88:91], v[112:115], v[32:35]
    ds_read_b64_tr_b16 v[68:69], v124 offset:0
    v_mfma_f32_16x16x32_bf16 v[36:39], v[88:91], v[116:119], v[36:39]
    ds_read_b64_tr_b16 v[70:71], v124 offset:8192
    v_mfma_f32_16x16x32_bf16 v[40:43], v[88:91], v[120:123], v[40:43]
    ds_read_b64_tr_b16 v[72:73], v125 offset:0
    v_mfma_f32_16x16x32_bf16 v[44:47], v[92:95], v[112:115], v[44:47]
    ds_read_b64_tr_b16 v[74:75], v125 offset:8192
    v_mfma_f32_16x16x32_bf16 v[48:51], v[92:95], v[116:119], v[48:51]
    ds_read_b64_tr_b16 v[76:77], v126 offset:0
    v_mfma_f32_16x16x32_bf16 v[52:55], v[92:95], v[120:123], v[52:55]
    ds_read_b64_tr_b16 v[78:79], v126 offset:8192
    v_mfma_f32_16x16x32_bf16 v[56:59], v[96:99], v[112:115], v[56:59]
    ds_read_b64_tr_b16 v[80:81], v127 offset:0
    v_mfma_f32_16x16x32_bf16 v[60:63], v[96:99], v[116:119], v[60:63]
    ds_read_b64_tr_b16 v[82:83], v127 offset:8192
    v_mfma_f32_16x16x32_bf16 v[64:67], v[96:99], v[120:123], v[64:67]
    s_waitcnt vmcnt(4) lgkmcnt(0)
    s_barrier
    s_add_u32 m0, s31, 0
    s_nop 0
    global_load_lds_dwordx4 v12, s[22:23]
    s_add_u32 m0, s34, 0
    s_nop 0
    global_load_lds_dwordx4 v13, s[22:23]
    s_add_u32 s22, s22, 262144
    s_addc_u32 s23, s23, 0
    v_add_u32 v2, 0, v16
    global_load_dwordx4 v[128:131], v2, s[16:17]
    v_add_u32 v2, 8192, v16
    global_load_dwordx4 v[132:135], v2, s[16:17]
    v_mfma_f32_16x16x32_bf16 v[20:23], v[68:71], v[100:103], v[20:23]
    ds_read_b128 v[112:115], v14 offset:320
    v_mfma_f32_16x16x32_bf16 v[24:27], v[68:71], v[104:107], v[24:27]
    ds_read_b128 v[116:119], v14 offset:15168
    v_mfma_f32_16x16x32_bf16 v[28:31], v[68:71], v[108:111], v[28:31]
    ds_read_b128 v[120:123], v14 offset:30016
    v_mfma_f32_16x16x32_bf16 v[32:35], v[72:75], v[100:103], v[32:35]
    ds_read_b64_tr_b16 v[84:85], v124 offset:16384
    v_mfma_f32_16x16x32_bf16 v[36:39], v[72:75], v[104:107], v[36:39]
    ds_read_b64_tr_b16 v[86:87], v124 offset:24576
    v_mfma_f32_16x16x32_bf16 v[40:43], v[72:75], v[108:111], v[40:43]
    ds_read_b64_tr_b16 v[88:89], v125 offset:16384
    v_mfma_f32_16x16x32_bf16 v[44:47], v[76:79], v[100:103], v[44:47]
    ds_read_b64_tr_b16 v[90:91], v125 offset:24576
    v_mfma_f32_16x16x32_bf16 v[48:51], v[76:79], v[104:107], v[48:51]
    ds_read_b64_tr_b16 v[92:93], v126 offset:16384
    v_mfma_f32_16x16x32_bf16 v[52:55], v[76:79], v[108:111], v[52:55]
    ds_read_b64_tr_b16 v[94:95], v126 offset:24576
    v_mfma_f32_16x16x32_bf16 v[56:59], v[80:83], v[100:103], v[56:59]
    ds_read_b64_tr_b16 v[96:97], v127 offset:16384
    v_mfma_f32_16x16x32_bf16 v[60:63], v[80:83], v[104:107], v[60:63]
    ds_read_b64_tr_b16 v[98:99], v127 offset:24576
    v_mfma_f32_16x16x32_bf16 v[64:67], v[80:83], v[108:111], v[64:67]
    s_waitcnt vmcnt(6) lgkmcnt(0)
    s_barrier
    s_add_u32 m0, s31, 16384
    s_nop 0
    global_load_lds_dwordx4 v12, s[22:23]
    s_add_u32 m0, s34, 16384
    s_nop 0
    global_load_lds_dwordx4 v13, s[22:23]
    s_add_u32 s22, s22, 262144
    s_addc_u32 s23, s23, 0
    v_add_u32 v2, 16384, v16
    global_load_dwordx4 v[136:139], v2, s[16:17]
    v_add_u32 v2, 0, v16
    global_load_dwordx4 v[140:143], v2, s[26:27]
    v_mfma_f32_16x16x32_bf16 v[20:23], v[84:87], v[112:115], v[20:23]
    ds_read_b128 v[100:103], v14 offset:384
    v_mfma_f32_16x16x32_bf16 v[24:27], v[84:87], v[116:119], v[24:27]
    ds_read_b128 v[104:107], v14 offset:15232
    v_mfma_f32_16x16x32_bf16 v[28:31], v[84:87], v[120:123], v[28:31]
    ds_read_b128 v[108:111], v14 offset:30080
    v_mfma_f32_16x16x32_bf16 v[32:35], v[88:91], v[112:115], v[32:35]
    ds_read_b64_tr_b16 v[68:69], v124 offset:32768
    v_mfma_f32_16x16x32_bf16 v[36:39], v[88:91], v[116:119], v[36:39]
    ds_read_b64_tr_b16 v[70:71], v124 offset:40960
    v_mfma_f32_16x16x32_bf16 v[40:43], v[88:91], v[120:123], v[40:43]
    ds_read_b64_tr_b16 v[72:73], v125 offset:32768
    v_mfma_f32_16x16x32_bf16 v[44:47], v[92:95], v[112:115], v[44:47]
    ds_read_b64_tr_b16 v[74:75], v125 offset:40960
    v_mfma_f32_16x16x32_bf16 v[48:51], v[92:95], v[116:119], v[48:51]
    ds_read_b64_tr_b16 v[76:77], v126 offset:32768
    v_mfma_f32_16x16x32_bf16 v[52:55], v[92:95], v[120:123], v[52:55]
    ds_read_b64_tr_b16 v[78:79], v126 offset:40960
    v_mfma_f32_16x16x32_bf16 v[56:59], v[96:99], v[112:115], v[56:59]
    ds_read_b64_tr_b16 v[80:81], v127 offset:32768
    v_mfma_f32_16x16x32_bf16 v[60:63], v[96:99], v[116:119], v[60:63]
    ds_read_b64_tr_b16 v[82:83], v127 offset:40960
    v_mfma_f32_16x16x32_bf16 v[64:67], v[96:99], v[120:123], v[64:67]
    s_waitcnt vmcnt(8) lgkmcnt(0)
    s_barrier
    s_add_u32 m0, s31, 32768
    s_nop 0
    global_load_lds_dwordx4 v12, s[22:23]
    s_add_u32 m0, s34, 32768
    s_nop 0
    global_load_lds_dwordx4 v13, s[22:23]
    s_add_u32 s22, s22, 262144
    s_addc_u32 s23, s23, 0
    v_add_u32 v2, 8192, v16
    global_load_dwordx4 v[144:147], v2, s[26:27]
    v_add_u32 v2, 16384, v16
    global_load_dwordx4 v[148:151], v2, s[26:27]
    v_mfma_f32_16x16x32_bf16 v[20:23], v[68:71], v[100:103], v[20:23]
    ds_read_b128 v[112:115], v14 offset:448
    v_mfma_f32_16x16x32_bf16 v[24:27], v[68:71], v[104:107], v[24:27]
    ds_read_b128 v[116:119], v14 offset:15296
    v_mfma_f32_16x16x32_bf16 v[28:31], v[68:71], v[108:111], v[28:31]
    ds_read_b128 v[120:123], v14 offset:30144
    v_mfma_f32_16x16x32_bf16 v[32:35], v[72:75], v[100:103], v[32:35]
    ds_read_b64_tr_b16 v[84:85], v124 offset:49152
    v_mfma_f32_16x16x32_bf16 v[36:39], v[72:75], v[104:107], v[36:39]
    ds_read_b64_tr_b16 v[86:87], v124 offset:57344
    v_mfma_f32_16x16x32_bf16 v[40:43], v[72:75], v[108:111], v[40:43]
    ds_read_b64_tr_b16 v[88:89], v125 offset:49152
    v_mfma_f32_16x16x32_bf16 v[44:47], v[76:79], v[100:103], v[44:47]
    ds_read_b64_tr_b16 v[90:91], v125 offset:57344
    v_mfma_f32_16x16x32_bf16 v[48:51], v[76:79], v[104:107], v[48:51]
    ds_read_b64_tr_b16 v[92:93], v126 offset:49152
    v_mfma_f32_16x16x32_bf16 v[52:55], v[76:79], v[108:111], v[52:55]
    ds_read_b64_tr_b16 v[94:95], v126 offset:57344
    v_mfma_f32_16x16x32_bf16 v[56:59], v[80:83], v[100:103], v[56:59]
    ds_read_b64_tr_b16 v[96:97], v127 offset:49152
    v_mfma_f32_16x16x32_bf16 v[60:63], v[80:83], v[104:107], v[60:63]
    ds_read_b64_tr_b16 v[98:99], v127 offset:57344
    v_mfma_f32_16x16x32_bf16 v[64:67], v[80:83], v[108:111], v[64:67]
    s_waitcnt vmcnt(10) lgkmcnt(0)
    s_barrier
    s_add_u32 m0, s31, 49152
    s_nop 0
    global_load_lds_dwordx4 v12, s[22:23]
    s_add_u32 m0, s34, 49152
    s_nop 0
    global_load_lds_dwordx4 v13, s[22:23]
    s_add_u32 s22, s22, 262144
    s_addc_u32 s23, s23, 0
    v_add_u32 v2, 0, v16
    global_load_dwordx4 v[152:155], v2, s[14:15]
    v_add_u32 v2, 8192, v16
    global_load_dwordx4 v[156:159], v2, s[14:15]
    v_mfma_f32_16x16x32_bf16 v[20:23], v[84:87], v[112:115], v[20:23]
    ds_read_b128 v[100:103], v14 offset:512
    v_mfma_f32_16x16x32_bf16 v[24:27], v[84:87], v[116:119], v[24:27]
    ds_read_b128 v[104:107], v14 offset:15360
    v_mfma_f32_16x16x32_bf16 v[28:31], v[84:87], v[120:123], v[28:31]
    ds_read_b128 v[108:111], v14 offset:30208
    v_mfma_f32_16x16x32_bf16 v[32:35], v[88:91], v[112:115], v[32:35]
    ds_read_b64_tr_b16 v[68:69], v124 offset:0
    v_mfma_f32_16x16x32_bf16 v[36:39], v[88:91], v[116:119], v[36:39]
    ds_read_b64_tr_b16 v[70:71], v124 offset:8192
    v_mfma_f32_16x16x32_bf16 v[40:43], v[88:91], v[120:123], v[40:43]
    ds_read_b64_tr_b16 v[72:73], v125 offset:0
    v_mfma_f32_16x16x32_bf16 v[44:47], v[92:95], v[112:115], v[44:47]
    ds_read_b64_tr_b16 v[74:75], v125 offset:8192
    v_mfma_f32_16x16x32_bf16 v[48:51], v[92:95], v[116:119], v[48:51]
    ds_read_b64_tr_b16 v[76:77], v126 offset:0
    v_mfma_f32_16x16x32_bf16 v[52:55], v[92:95], v[120:123], v[52:55]
    ds_read_b64_tr_b16 v[78:79], v126 offset:8192
    v_mfma_f32_16x16x32_bf16 v[56:59], v[96:99], v[112:115], v[56:59]
    ds_read_b64_tr_b16 v[80:81], v127 offset:0
    v_mfma_f32_16x16x32_bf16 v[60:63], v[96:99], v[116:119], v[60:63]
    ds_read_b64_tr_b16 v[82:83], v127 offset:8192
    v_mfma_f32_16x16x32_bf16 v[64:67], v[96:99], v[120:123], v[64:67]
    s_waitcnt vmcnt(10) lgkmcnt(0)
    s_barrier
    s_add_u32 m0, s31, 0
    s_nop 0
    global_load_lds_dwordx4 v12, s[22:23]
    s_add_u32 m0, s34, 0
    s_nop 0
    global_load_lds_dwordx4 v13, s[22:23]
    s_add_u32 s22, s22, 262144
    s_addc_u32 s23, s23, 0
    v_add_u32 v2, 16384, v16
    global_load_dwordx4 v[160:163], v2, s[14:15]
    v_add_u32 v2, 0, v16
    global_load_dwordx4 v[164:167], v2, s[32:33]
    v_mfma_f32_16x16x32_bf16 v[20:23], v[68:71], v[100:103], v[20:23]
    ds_read_b128 v[112:115], v14 offset:576
    v_mfma_f32_16x16x32_bf16 v[24:27], v[68:71], v[104:107], v[24:27]
    ds_read_b128 v[116:119], v14 offset:15424
    v_mfma_f32_16x16x32_bf16 v[28:31], v[68:71], v[108:111], v[28:31]
    ds_read_b128 v[120:123], v14 offset:30272
    v_mfma_f32_16x16x32_bf16 v[32:35], v[72:75], v[100:103], v[32:35]
    ds_read_b64_tr_b16 v[84:85], v124 offset:16384
    v_mfma_f32_16x16x32_bf16 v[36:39], v[72:75], v[104:107], v[36:39]
    ds_read_b64_tr_b16 v[86:87], v124 offset:24576
    v_mfma_f32_16x16x32_bf16 v[40:43], v[72:75], v[108:111], v[40:43]
    ds_read_b64_tr_b16 v[88:89], v125 offset:16384
    v_mfma_f32_16x16x32_bf16 v[44:47], v[76:79], v[100:103], v[44:47]
    ds_read_b64_tr_b16 v[90:91], v125 offset:24576
    v_mfma_f32_16x16x32_bf16 v[48:51], v[76:79], v[104:107], v[48:51]
    ds_read_b64_tr_b16 v[92:93], v126 offset:16384
    v_mfma_f32_16x16x32_bf16 v[52:55], v[76:79], v[108:111], v[52:55]
    ds_read_b64_tr_b16 v[94:95], v126 offset:24576
    v_mfma_f32_16x16x32_bf16 v[56:59], v[80:83], v[100:103], v[56:59]
    ds_read_b64_tr_b16 v[96:97], v127 offset:16384
    v_mfma_f32_16x16x32_bf16 v[60:63], v[80:83], v[104:107], v[60:63]
    ds_read_b64_tr_b16 v[98:99], v127 offset:24576
    v_mfma_f32_16x16x32_bf16 v[64:67], v[80:83], v[108:111], v[64:67]
    s_waitcnt vmcnt(10) lgkmcnt(0)
    s_barrier
    s_add_u32 m0, s31, 16384
    s_nop 0
    global_load_lds_dwordx4 v12, s[22:23]
    s_add_u32 m0, s34, 16384
    s_nop 0
    global_load_lds_dwordx4 v13, s[22:23]
    s_add_u32 s22, s22, 262144
    s_addc_u32 s23, s23, 0
    v_add_u32 v2, 8192, v16
    global_load_dwordx4 v[168:171], v2, s[32:33]
    v_add_u32 v2, 16384, v16
    global_load_dwordx4 v[172:175], v2, s[32:33]
    v_mfma_f32_16x16x32_bf16 v[20:23], v[84:87], v[112:115], v[20:23]
    ds_read_b128 v[100:103], v14 offset:640
    v_mfma_f32_16x16x32_bf16 v[24:27], v[84:87], v[116:119], v[24:27]
    ds_read_b128 v[104:107], v14 offset:15488
    v_mfma_f32_16x16x32_bf16 v[28:31], v[84:87], v[120:123], v[28:31]
    ds_read_b128 v[108:111], v14 offset:30336
    v_mfma_f32_16x16x32_bf16 v[32:35], v[88:91], v[112:115], v[32:35]
    ds_read_b64_tr_b16 v[68:69], v124 offset:32768
    v_mfma_f32_16x16x32_bf16 v[36:39], v[88:91], v[116:119], v[36:39]
    ds_read_b64_tr_b16 v[70:71], v124 offset:40960
    v_mfma_f32_16x16x32_bf16 v[40:43], v[88:91], v[120:123], v[40:43]
    ds_read_b64_tr_b16 v[72:73], v125 offset:32768
    v_mfma_f32_16x16x32_bf16 v[44:47], v[92:95], v[112:115], v[44:47]
    ds_read_b64_tr_b16 v[74:75], v125 offset:40960
    v_mfma_f32_16x16x32_bf16 v[48:51], v[92:95], v[116:119], v[48:51]
    ds_read_b64_tr_b16 v[76:77], v126 offset:32768
    v_mfma_f32_16x16x32_bf16 v[52:55], v[92:95], v[120:123], v[52:55]
    ds_read_b64_tr_b16 v[78:79], v126 offset:40960
    v_mfma_f32_16x16x32_bf16 v[56:59], v[96:99], v[112:115], v[56:59]
    ds_read_b64_tr_b16 v[80:81], v127 offset:32768
    v_mfma_f32_16x16x32_bf16 v[60:63], v[96:99], v[116:119], v[60:63]
    ds_read_b64_tr_b16 v[82:83], v127 offset:40960
    v_mfma_f32_16x16x32_bf16 v[64:67], v[96:99], v[120:123], v[64:67]
    s_waitcnt vmcnt(10) lgkmcnt(0)
    s_barrier
    v_mfma_f32_16x16x32_bf16 v[20:23], v[68:71], v[100:103], v[20:23]
    ds_read_b128 v[112:115], v14 offset:704
    v_mfma_f32_16x16x32_bf16 v[24:27], v[68:71], v[104:107], v[24:27]
    ds_read_b128 v[116:119], v14 offset:15552
    v_mfma_f32_16x16x32_bf16 v[28:31], v[68:71], v[108:111], v[28:31]
    ds_read_b128 v[120:123], v14 offset:30400
    v_mfma_f32_16x16x32_bf16 v[32:35], v[72:75], v[100:103], v[32:35]
    ds_read_b64_tr_b16 v[84:85], v124 offset:49152
    v_mfma_f32_16x16x32_bf16 v[36:39], v[72:75], v[104:107], v[36:39]
    ds_read_b64_tr_b16 v[86:87], v124 offset:57344
    v_mfma_f32_16x16x32_bf16 v[40:43], v[72:75], v[108:111], v[40:43]
    ds_read_b64_tr_b16 v[88:89], v125 offset:49152
    v_mfma_f32_16x16x32_bf16 v[44:47], v[76:79], v[100:103], v[44:47]
    ds_read_b64_tr_b16 v[90:91], v125 offset:57344
    v_mfma_f32_16x16x32_bf16 v[48:51], v[76:79], v[104:107], v[48:51]
    ds_read_b64_tr_b16 v[92:93], v126 offset:49152
    v_mfma_f32_16x16x32_bf16 v[52:55], v[76:79], v[108:111], v[52:55]
    ds_read_b64_tr_b16 v[94:95], v126 offset:57344
    v_mfma_f32_16x16x32_bf16 v[56:59], v[80:83], v[100:103], v[56:59]
    ds_read_b64_tr_b16 v[96:97], v127 offset:49152
    v_mfma_f32_16x16x32_bf16 v[60:63], v[80:83], v[104:107], v[60:63]
    ds_read_b64_tr_b16 v[98:99], v127 offset:57344
    v_mfma_f32_16x16x32_bf16 v[64:67], v[80:83], v[108:111], v[64:67]
    s_waitcnt vmcnt(6) lgkmcnt(0)
    s_barrier
    v_mfma_f32_16x16x32_bf16 v[20:23], v[84:87], v[112:115], v[20:23]
    ds_read_b128 v[100:103], v14 offset:768
    v_mfma_f32_16x16x32_bf16 v[24:27], v[84:87], v[116:119], v[24:27]
    ds_read_b128 v[104:107], v14 offset:15616
    v_mfma_f32_16x16x32_bf16 v[28:31], v[84:87], v[120:123], v[28:31]
    ds_read_b128 v[108:111], v14 offset:30464
    v_mfma_f32_16x16x32_bf16 v[32:35], v[88:91], v[112:115], v[32:35]
    ds_read_b64_tr_b16 v[68:69], v124 offset:0
    v_mfma_f32_16x16x32_bf16 v[36:39], v[88:91], v[116:119], v[36:39]
    ds_read_b64_tr_b16 v[70:71], v124 offset:8192
    v_mfma_f32_16x16x32_bf16 v[40:43], v[88:91], v[120:123], v[40:43]
    ds_read_b64_tr_b16 v[72:73], v125 offset:0
    v_mfma_f32_16x16x32_bf16 v[44:47], v[92:95], v[112:115], v[44:47]
    ds_read_b64_tr_b16 v[74:75], v125 offset:8192
    v_mfma_f32_16x16x32_bf16 v[48:51], v[92:95], v[116:119], v[48:51]
    ds_read_b64_tr_b16 v[76:77], v126 offset:0
    v_mfma_f32_16x16x32_bf16 v[52:55], v[92:95], v[120:123], v[52:55]
    ds_read_b64_tr_b16 v[78:79], v126 offset:8192
    v_mfma_f32_16x16x32_bf16 v[56:59], v[96:99], v[112:115], v[56:59]
    ds_read_b64_tr_b16 v[80:81], v127 offset:0
    v_mfma_f32_16x16x32_bf16 v[60:63], v[96:99], v[116:119], v[60:63]
    ds_read_b64_tr_b16 v[82:83], v127 offset:8192
    v_mfma_f32_16x16x32_bf16 v[64:67], v[96:99], v[120:123], v[64:67]
    s_waitcnt vmcnt(2) lgkmcnt(0)
    s_barrier
    v_mfma_f32_16x16x32_bf16 v[20:23], v[68:71], v[100:103], v[20:23]
    ds_read_b128 v[112:115], v14 offset:832
    v_mfma_f32_16x16x32_bf16 v[24:27], v[68:71], v[104:107], v[24:27]
    ds_read_b128 v[116:119], v14 offset:15680
    v_mfma_f32_16x16x32_bf16 v[28:31], v[68:71], v[108:111], v[28:31]
    ds_read_b128 v[120:123], v14 offset:30528
    v_mfma_f32_16x16x32_bf16 v[32:35], v[72:75], v[100:103], v[32:35]
    ds_read_b64_tr_b16 v[84:85], v124 offset:16384
    v_mfma_f32_16x16x32_bf16 v[36:39], v[72:75], v[104:107], v[36:39]
    ds_read_b64_tr_b16 v[86:87], v124 offset:24576
    v_mfma_f32_16x16x32_bf16 v[40:43], v[72:75], v[108:111], v[40:43]
    ds_read_b64_tr_b16 v[88:89], v125 offset:16384
    v_mfma_f32_16x16x32_bf16 v[44:47], v[76:79], v[100:103], v[44:47]
    ds_read_b64_tr_b16 v[90:91], v125 offset:24576
    v_mfma_f32_16x16x32_bf16 v[48:51], v[76:79], v[104:107], v[48:51]
    ds_read_b64_tr_b16 v[92:93], v126 offset:16384
    v_mfma_f32_16x16x32_bf16 v[52:55], v[76:79], v[108:111], v[52:55]
    ds_read_b64_tr_b16 v[94:95], v126 offset:24576
    v_mfma_f32_16x16x32_bf16 v[56:59], v[80:83], v[100:103], v[56:59]
    ds_read_b64_tr_b16 v[96:97], v127 offset:16384
    v_mfma_f32_16x16x32_bf16 v[60:63], v[80:83], v[104:107], v[60:63]
    ds_read_b64_tr_b16 v[98:99], v127 offset:24576
    v_mfma_f32_16x16x32_bf16 v[64:67], v[80:83], v[108:111], v[64:67]
    s_waitcnt lgkmcnt(0)
    s_barrier
    v_add_u32 v18, 52224, v17
    v_mfma_f32_16x16x32_bf16 v[20:23], v[84:87], v[112:115], v[20:23]
    v_mfma_f32_16x16x32_bf16 v[24:27], v[84:87], v[116:119], v[24:27]
    v_mfma_f32_16x16x32_bf16 v[28:31], v[84:87], v[120:123], v[28:31]
    v_mfma_f32_16x16x32_bf16 v[32:35], v[88:91], v[112:115], v[32:35]
    v_mfma_f32_16x16x32_bf16 v[36:39], v[88:91], v[116:119], v[36:39]
    v_mfma_f32_16x16x32_bf16 v[40:43], v[88:91], v[120:123], v[40:43]
    s_waitcnt vmcnt(0)
    ds_write_b128 v17, v[128:131] offset:0
    ds_write_b128 v18, v[152:155] offset:0
    ds_write_b128 v17, v[132:135] offset:8704
    ds_write_b128 v18, v[156:159] offset:8704
    ds_write_b128 v17, v[136:139] offset:17408
    ds_write_b128 v18, v[160:163] offset:17408
    ds_write_b128 v17, v[140:143] offset:26112
    ds_write_b128 v18, v[164:167] offset:26112
    ds_write_b128 v17, v[144:147] offset:34816
    ds_write_b128 v18, v[168:171] offset:34816
    ds_write_b128 v17, v[148:151] offset:43520
    ds_write_b128 v18, v[172:175] offset:43520
    v_mfma_f32_16x16x32_bf16 v[44:47], v[92:95], v[112:115], v[44:47]
    v_mfma_f32_16x16x32_bf16 v[48:51], v[92:95], v[116:119], v[48:51]
    v_mfma_f32_16x16x32_bf16 v[52:55], v[92:95], v[120:123], v[52:55]
    v_mfma_f32_16x16x32_bf16 v[56:59], v[96:99], v[112:115], v[56:59]
    v_mfma_f32_16x16x32_bf16 v[60:63], v[96:99], v[116:119], v[60:63]
    v_mfma_f32_16x16x32_bf16 v[64:67], v[96:99], v[120:123], v[64:67]
    s_mul_i32 s29, s25, 26112
    s_lshl_b32 s30, s28, 7
    s_add_u32 s29, s29, s30
    v_mul_u32_u24 v5, 544, v3
    v_lshlrev_b32 v6, 3, v4
    v_add3_u32 v2, v5, v6, s29
    s_nop 4
    v_cvt_pk_bf16_f32 v6, v20, v21
    v_cvt_pk_bf16_f32 v7, v22, v23
    ds_write_b64 v2, v[6:7] offset:0
    v_cvt_pk_bf16_f32 v8, v24, v25
    v_cvt_pk_bf16_f32 v9, v26, v27
    ds_write_b64 v2, v[8:9] offset:8704
    v_cvt_pk_bf16_f32 v6, v28, v29
    v_cvt_pk_bf16_f32 v7, v30, v31
    ds_write_b64 v2, v[6:7] offset:17408
    v_cvt_pk_bf16_f32 v8, v32, v33
    v_cvt_pk_bf16_f32 v9, v34, v35
    ds_write_b64 v2, v[8:9] offset:32
    v_cvt_pk_bf16_f32 v6, v36, v37
    v_cvt_pk_bf16_f32 v7, v38, v39
    ds_write_b64 v2, v[6:7] offset:8736
    v_cvt_pk_bf16_f32 v8, v40, v41
    v_cvt_pk_bf16_f32 v9, v42, v43
    ds_write_b64 v2, v[8:9] offset:17440
    v_cvt_pk_bf16_f32 v6, v44, v45
    v_cvt_pk_bf16_f32 v7, v46, v47
    ds_write_b64 v2, v[6:7] offset:64
    v_cvt_pk_bf16_f32 v8, v48, v49
    v_cvt_pk_bf16_f32 v9, v50, v51
    ds_write_b64 v2, v[8:9] offset:8768
    v_cvt_pk_bf16_f32 v6, v52, v53
    v_cvt_pk_bf16_f32 v7, v54, v55
    ds_write_b64 v2, v[6:7] offset:17472
    v_cvt_pk_bf16_f32 v8, v56, v57
    v_cvt_pk_bf16_f32 v9, v58, v59
    ds_write_b64 v2, v[8:9] offset:96
    v_cvt_pk_bf16_f32 v6, v60, v61
    v_cvt_pk_bf16_f32 v7, v62, v63
    ds_write_b64 v2, v[6:7] offset:8800
    v_cvt_pk_bf16_f32 v8, v64, v65
    v_cvt_pk_bf16_f32 v9, v66, v67
    ds_write_b64 v2, v[8:9] offset:17504
    s_cmp_lt_u32 s24, 6
    s_cselect_b32 s31, 1, 0
    s_cmp_ge_u32 s24, 3
    s_cselect_b32 s25, 1, 0
    s_mul_i32 s30, s25, 3
    s_sub_u32 s28, s24, s30
    s_waitcnt lgkmcnt(0)
    s_barrier
    s_cmp_eq_u32 s31, 0
    s_cbranch_scc1 k1_pf
    s_mul_i32 s29, s25, 26112
    v_mul_u32_u24 v5, 544, v3
    v_lshlrev_b32 v6, 4, v4
    v_add3_u32 v2, v5, v6, s29
    v_add_u32 v8, 104448, v2
    s_mul_i32 s30, s28, 8704
    v_add_u32 v2, s30, v2
    ds_read_b128 v[204:207], v2 offset:0
    ds_read_b128 v[208:211], v2 offset:64
    ds_read_b128 v[212:215], v2 offset:128
    ds_read_b128 v[216:219], v2 offset:192
    ds_read_b128 v[220:223], v2 offset:256
    ds_read_b128 v[224:227], v2 offset:320
    ds_read_b128 v[228:231], v2 offset:384
    ds_read_b128 v[232:235], v2 offset:448
    v_mov_b32 v236, 0
    v_mov_b32 v237, 0
    v_mov_b32 v238, 0
    v_mov_b32 v239, 0
    v_mov_b32 v240, 0
    v_mov_b32 v241, 0
    v_mov_b32 v242, 0
    v_mov_b32 v243, 0
    v_mov_b32 v244, 0
    v_mov_b32 v245, 0
    v_mov_b32 v246, 0
    v_mov_b32 v247, 0
    s_waitcnt lgkmcnt(0)
    ds_read_b128 v[68:71], v8 offset:0
    ds_read_b128 v[72:75], v8 offset:64
    ds_read_b128 v[76:79], v8 offset:128
    ds_read_b128 v[80:83], v8 offset:192
    ds_read_b128 v[84:87], v8 offset:256
    ds_read_b128 v[88:91], v8 offset:320
    ds_read_b128 v[92:95], v8 offset:384
    ds_read_b128 v[96:99], v8 offset:448
    s_waitcnt lgkmcnt(0)
    v_mfma_f32_16x16x32_bf16 v[236:239], v[68:71], v[204:207], v[236:239]
    v_mfma_f32_16x16x32_bf16 v[236:239], v[72:75], v[208:211], v[236:239]
    v_mfma_f32_16x16x32_bf16 v[236:239], v[76:79], v[212:215], v[236:239]
    v_mfma_f32_16x16x32_bf16 v[236:239], v[80:83], v[216:219], v[236:239]
    v_mfma_f32_16x16x32_bf16 v[236:239], v[84:87], v[220:223], v[236:239]
    v_mfma_f32_16x16x32_bf16 v[236:239], v[88:91], v[224:227], v[236:239]
    v_mfma_f32_16x16x32_bf16 v[236:239], v[92:95], v[228:231], v[236:239]
    v_mfma_f32_16x16x32_bf16 v[236:239], v[96:99], v[232:235], v[236:239]
    ds_read_b128 v[100:103], v8 offset:8704
    ds_read_b128 v[104:107], v8 offset:8768
    ds_read_b128 v[108:111], v8 offset:8832
    ds_read_b128 v[112:115], v8 offset:8896
    ds_read_b128 v[116:119], v8 offset:8960
    ds_read_b128 v[120:123], v8 offset:9024
    ds_read_b128 v[124:127], v8 offset:9088
    ds_read_b128 v[128:131], v8 offset:9152
    s_waitcnt lgkmcnt(0)
    v_mfma_f32_16x16x32_bf16 v[240:243], v[100:103], v[204:207], v[240:243]
    v_mfma_f32_16x16x32_bf16 v[240:243], v[104:107], v[208:211], v[240:243]
    v_mfma_f32_16x16x32_bf16 v[240:243], v[108:111], v[212:215], v[240:243]
    v_mfma_f32_16x16x32_bf16 v[240:243], v[112:115], v[216:219], v[240:243]
    v_mfma_f32_16x16x32_bf16 v[240:243], v[116:119], v[220:223], v[240:243]
    v_mfma_f32_16x16x32_bf16 v[240:243], v[120:123], v[224:227], v[240:243]
    v_mfma_f32_16x16x32_bf16 v[240:243], v[124:127], v[228:231], v[240:243]
    v_mfma_f32_16x16x32_bf16 v[240:243], v[128:131], v[232:235], v[240:243]
    ds_read_b128 v[132:135], v8 offset:17408
    ds_read_b128 v[136:139], v8 offset:17472
    ds_read_b128 v[140:143], v8 offset:17536
    ds_read_b128 v[144:147], v8 offset:17600
    ds_read_b128 v[148:151], v8 offset:17664
    ds_read_b128 v[152:155], v8 offset:17728
    ds_read_b128 v[156:159], v8 offset:17792
    ds_read_b128 v[160:163], v8 offset:17856
    s_waitcnt lgkmcnt(0)
    v_mfma_f32_16x16x32_bf16 v[244:247], v[132:135], v[204:207], v[244:247]
    v_mfma_f32_16x16x32_bf16 v[244:247], v[136:139], v[208:211], v[244:247]
    v_mfma_f32_16x16x32_bf16 v[244:247], v[140:143], v[212:215], v[244:247]
    v_mfma_f32_16x16x32_bf16 v[244:247], v[144:147], v[216:219], v[244:247]
    v_mfma_f32_16x16x32_bf16 v[244:247], v[148:151], v[220:223], v[244:247]
    v_mfma_f32_16x16x32_bf16 v[244:247], v[152:155], v[224:227], v[244:247]
    v_mfma_f32_16x16x32_bf16 v[244:247], v[156:159], v[228:231], v[244:247]
    v_mfma_f32_16x16x32_bf16 v[244:247], v[160:163], v[232:235], v[244:247]
    v_add_u32 v19, s29, v19
    v_add_u32 v19, 52224, v19
    s_nop 7
    s_nop 1
    v_cvt_pk_bf16_f32 v6, v236, v237
    v_lshlrev_b32 v236, 16, v6
    v_and_b32 v237, 0xffff0000, v6
    v_cvt_pk_bf16_f32 v6, v238, v239
    v_lshlrev_b32 v238, 16, v6
    v_and_b32 v239, 0xffff0000, v6
    v_cvt_pk_bf16_f32 v6, v240, v241
    v_lshlrev_b32 v240, 16, v6
    v_and_b32 v241, 0xffff0000, v6
    v_cvt_pk_bf16_f32 v6, v242, v243
    v_lshlrev_b32 v242, 16, v6
    v_and_b32 v243, 0xffff0000, v6
    v_cvt_pk_bf16_f32 v6, v244, v245
    v_lshlrev_b32 v244, 16, v6
    v_and_b32 v245, 0xffff0000, v6
    v_cvt_pk_bf16_f32 v6, v246, v247
    v_lshlrev_b32 v246, 16, v6
    v_and_b32 v247, 0xffff0000, v6
    v_max3_f32 v6, v236, v237, v238
    v_max3_f32 v6, v6, v239, v240
    v_max3_f32 v6, v6, v241, v242
    v_max3_f32 v6, v6, v243, v244
    v_max3_f32 v6, v6, v245, v246
    v_max_f32 v6, v6, v247
    v_mov_b32 v7, v6
    s_nop 1
    v_permlane32_swap_b32 v6, v7
    v_max_f32 v6, v6, v7
    v_mov_b32 v7, v6
    s_nop 1
    v_permlane16_swap_b32 v6, v7
    v_max_f32 v6, v6, v7
    s_mov_b32 s29, 0x3db8aa3b
    v_mul_f32 v6, s29, v6
    v_fma_f32 v236, v236, s29, -v6
    v_fma_f32 v237, v237, s29, -v6
    v_fma_f32 v238, v238, s29, -v6
    v_fma_f32 v239, v239, s29, -v6
    v_fma_f32 v240, v240, s29, -v6
    v_fma_f32 v241, v241, s29, -v6
    v_fma_f32 v242, v242, s29, -v6
    v_fma_f32 v243, v243, s29, -v6
    v_fma_f32 v244, v244, s29, -v6
    v_fma_f32 v245, v245, s29, -v6
    v_fma_f32 v246, v246, s29, -v6
    v_fma_f32 v247, v247, s29, -v6
    v_exp_f32 v236, v236
    v_exp_f32 v237, v237
    v_exp_f32 v238, v238
    v_exp_f32 v239, v239
    v_exp_f32 v240, v240
    v_exp_f32 v241, v241
    v_exp_f32 v242, v242
    v_exp_f32 v243, v243
    v_exp_f32 v244, v244
    v_exp_f32 v245, v245
    v_exp_f32 v246, v246
    v_exp_f32 v247, v247
    s_nop 0
    v_add_f32 v6, v236, v237
    v_add_f32 v6, v6, v238
    v_add_f32 v6, v6, v239
    v_add_f32 v6, v6, v240
    v_add_f32 v6, v6, v241
    v_add_f32 v6, v6, v242
    v_add_f32 v6, v6, v243
    v_add_f32 v6, v6, v244
    v_add_f32 v6, v6, v245
    v_add_f32 v6, v6, v246
    v_add_f32 v6, v6, v247
    v_mov_b32 v7, v6
    s_nop 1
    v_permlane32_swap_b32 v6, v7
    v_add_f32 v6, v6, v7
    v_mov_b32 v7, v6
    s_nop 1
    v_permlane16_swap_b32 v6, v7
    v_add_f32 v6, v6, v7
    v_rcp_f32 v6, v6
    s_nop 0
    v_mul_f32 v236, v236, v6
    v_mul_f32 v237, v237, v6
    v_mul_f32 v238, v238, v6
    v_mul_f32 v239, v239, v6
    v_mul_f32 v240, v240, v6
    v_mul_f32 v241, v241, v6
    v_mul_f32 v242, v242, v6
    v_mul_f32 v243, v243, v6
    v_mul_f32 v244, v244, v6
    v_mul_f32 v245, v245, v6
    v_mul_f32 v246, v246, v6
    v_mul_f32 v247, v247, v6
    v_cvt_pk_bf16_f32 v248, v236, v237
    v_cvt_pk_bf16_f32 v249, v238, v239
    v_cvt_pk_bf16_f32 v250, v240, v241
    v_cvt_pk_bf16_f32 v251, v242, v243
    v_cvt_pk_bf16_f32 v252, v244, v245
    v_cvt_pk_bf16_f32 v253, v246, v247
    v_mov_b32 v68, 0
    v_mov_b32 v69, 0
    v_mov_b32 v70, 0
    v_mov_b32 v71, 0
    v_mov_b32 v72, 0
    v_mov_b32 v73, 0
    v_mov_b32 v74, 0
    v_mov_b32 v75, 0
    v_mov_b32 v76, 0
    v_mov_b32 v77, 0
    v_mov_b32 v78, 0
    v_mov_b32 v79, 0
    v_mov_b32 v80, 0
    v_mov_b32 v81, 0
    v_mov_b32 v82, 0
    v_mov_b32 v83, 0
    v_mov_b32 v84, 0
    v_mov_b32 v85, 0
    v_mov_b32 v86, 0
    v_mov_b32 v87, 0
    v_mov_b32 v88, 0
    v_mov_b32 v89, 0
    v_mov_b32 v90, 0
    v_mov_b32 v91, 0
    v_mov_b32 v92, 0
    v_mov_b32 v93, 0
    v_mov_b32 v94, 0
    v_mov_b32 v95, 0
    v_mov_b32 v96, 0
    v_mov_b32 v97, 0
    v_mov_b32 v98, 0
    v_mov_b32 v99, 0
    v_mov_b32 v100, 0
    v_mov_b32 v101, 0
    v_mov_b32 v102, 0
    v_mov_b32 v103, 0
    v_mov_b32 v104, 0
    v_mov_b32 v105, 0
    v_mov_b32 v106, 0
    v_mov_b32 v107, 0
    v_mov_b32 v108, 0
    v_mov_b32 v109, 0
    v_mov_b32 v110, 0
    v_mov_b32 v111, 0
    v_mov_b32 v112, 0
    v_mov_b32 v113, 0
    v_mov_b32 v114, 0
    v_mov_b32 v115, 0
    v_mov_b32 v116, 0
    v_mov_b32 v117, 0
    v_mov_b32 v118, 0
    v_mov_b32 v119, 0
    v_mov_b32 v120, 0
    v_mov_b32 v121, 0
    v_mov_b32 v122, 0
    v_mov_b32 v123, 0
    v_mov_b32 v124, 0
    v_mov_b32 v125, 0
    v_mov_b32 v126, 0
    v_mov_b32 v127, 0
    v_mov_b32 v128, 0
    v_mov_b32 v129, 0
    v_mov_b32 v130, 0
    v_mov_b32 v131, 0
    ds_read_b64_tr_b16 v[204:205], v19 offset:0
    ds_read_b64_tr_b16 v[206:207], v19 offset:8704
    ds_read_b64_tr_b16 v[132:133], v19 offset:17408
    ds_read_b64_tr_b16 v[208:209], v19 offset:32
    ds_read_b64_tr_b16 v[210:211], v19 offset:8736
    ds_read_b64_tr_b16 v[134:135], v19 offset:17440
    ds_read_b64_tr_b16 v[212:213], v19 offset:64
    ds_read_b64_tr_b16 v[214:215], v19 offset:8768
    ds_read_b64_tr_b16 v[136:137], v19 offset:17472
    ds_read_b64_tr_b16 v[216:217], v19 offset:96
    ds_read_b64_tr_b16 v[218:219], v19 offset:8800
    ds_read_b64_tr_b16 v[138:139], v19 offset:17504
    s_waitcnt lgkmcnt(9)
    v_mfma_f32_16x16x32_bf16 v[68:71], v[204:207], v[248:251], v[68:71]
    ds_read_b64_tr_b16 v[204:205], v19 offset:128
    ds_read_b64_tr_b16 v[206:207], v19 offset:8832
    ds_read_b64_tr_b16 v[140:141], v19 offset:17536
    s_waitcnt lgkmcnt(9)
    v_mfma_f32_16x16x32_bf16 v[72:75], v[208:211], v[248:251], v[72:75]
    ds_read_b64_tr_b16 v[208:209], v19 offset:160
    ds_read_b64_tr_b16 v[210:211], v19 offset:8864
    ds_read_b64_tr_b16 v[142:143], v19 offset:17568
    s_waitcnt lgkmcnt(9)
    v_mfma_f32_16x16x32_bf16 v[76:79], v[212:215], v[248:251], v[76:79]
    ds_read_b64_tr_b16 v[212:213], v19 offset:192
    ds_read_b64_tr_b16 v[214:215], v19 offset:8896
    ds_read_b64_tr_b16 v[144:145], v19 offset:17600
    s_waitcnt lgkmcnt(9)
    v_mfma_f32_16x16x32_bf16 v[80:83], v[216:219], v[248:251], v[80:83]
    ds_read_b64_tr_b16 v[216:217], v19 offset:224
    ds_read_b64_tr_b16 v[218:219], v19 offset:8928
    ds_read_b64_tr_b16 v[146:147], v19 offset:17632
    s_waitcnt lgkmcnt(9)
    v_mfma_f32_16x16x32_bf16 v[84:87], v[204:207], v[248:251], v[84:87]
    ds_read_b64_tr_b16 v[204:205], v19 offset:256
    ds_read_b64_tr_b16 v[206:207], v19 offset:8960
    ds_read_b64_tr_b16 v[148:149], v19 offset:17664
    s_waitcnt lgkmcnt(9)
    v_mfma_f32_16x16x32_bf16 v[88:91], v[208:211], v[248:251], v[88:91]
    ds_read_b64_tr_b16 v[208:209], v19 offset:288
    ds_read_b64_tr_b16 v[210:211], v19 offset:8992
    ds_read_b64_tr_b16 v[150:151], v19 offset:17696
    s_waitcnt lgkmcnt(9)
    v_mfma_f32_16x16x32_bf16 v[92:95], v[212:215], v[248:251], v[92:95]
    ds_read_b64_tr_b16 v[212:213], v19 offset:320
    ds_read_b64_tr_b16 v[214:215], v19 offset:9024
    ds_read_b64_tr_b16 v[152:153], v19 offset:17728
    s_waitcnt lgkmcnt(9)
    v_mfma_f32_16x16x32_bf16 v[96:99], v[216:219], v[248:251], v[96:99]
    ds_read_b64_tr_b16 v[216:217], v19 offset:352
    ds_read_b64_tr_b16 v[218:219], v19 offset:9056
    ds_read_b64_tr_b16 v[154:155], v19 offset:17760
    s_waitcnt lgkmcnt(9)
    v_mfma_f32_16x16x32_bf16 v[100:103], v[204:207], v[248:251], v[100:103]
    ds_read_b64_tr_b16 v[204:205], v19 offset:384
    ds_read_b64_tr_b16 v[206:207], v19 offset:9088
    ds_read_b64_tr_b16 v[156:157], v19 offset:17792
    s_waitcnt lgkmcnt(9)
    v_mfma_f32_16x16x32_bf16 v[104:107], v[208:211], v[248:251], v[104:107]
    ds_read_b64_tr_b16 v[208:209], v19 offset:416
    ds_read_b64_tr_b16 v[210:211], v19 offset:9120
    ds_read_b64_tr_b16 v[158:159], v19 offset:17824
    s_waitcnt lgkmcnt(9)
    v_mfma_f32_16x16x32_bf16 v[108:111], v[212:215], v[248:251], v[108:111]
    ds_read_b64_tr_b16 v[212:213], v19 offset:448
    ds_read_b64_tr_b16 v[214:215], v19 offset:9152
    ds_read_b64_tr_b16 v[160:161], v19 offset:17856
    s_waitcnt lgkmcnt(9)
    v_mfma_f32_16x16x32_bf16 v[112:115], v[216:219], v[248:251], v[112:115]
    ds_read_b64_tr_b16 v[216:217], v19 offset:480
    ds_read_b64_tr_b16 v[218:219], v19 offset:9184
    ds_read_b64_tr_b16 v[162:163], v19 offset:17888
    s_waitcnt lgkmcnt(9)
    v_mfma_f32_16x16x32_bf16 v[116:119], v[204:207], v[248:251], v[116:119]
    s_waitcnt lgkmcnt(6)
    v_mfma_f32_16x16x32_bf16 v[120:123], v[208:211], v[248:251], v[120:123]
    s_waitcnt lgkmcnt(3)
    v_mfma_f32_16x16x32_bf16 v[124:127], v[212:215], v[248:251], v[124:127]
    s_waitcnt lgkmcnt(0)
    v_mfma_f32_16x16x32_bf16 v[128:131], v[216:219], v[248:251], v[128:131]
    s_nop 7
    v_mfma_f32_16x16x16_bf16 v[68:71], v[132:133], v[252:253], v[68:71]
    v_mfma_f32_16x16x16_bf16 v[72:75], v[134:135], v[252:253], v[72:75]
    v_mfma_f32_16x16x16_bf16 v[76:79], v[136:137], v[252:253], v[76:79]
    v_mfma_f32_16x16x16_bf16 v[80:83], v[138:139], v[252:253], v[80:83]
    v_mfma_f32_16x16x16_bf16 v[84:87], v[140:141], v[252:253], v[84:87]
    v_mfma_f32_16x16x16_bf16 v[88:91], v[142:143], v[252:253], v[88:91]
    v_mfma_f32_16x16x16_bf16 v[92:95], v[144:145], v[252:253], v[92:95]
    v_mfma_f32_16x16x16_bf16 v[96:99], v[146:147], v[252:253], v[96:99]
    v_mfma_f32_16x16x16_bf16 v[100:103], v[148:149], v[252:253], v[100:103]
    v_mfma_f32_16x16x16_bf16 v[104:107], v[150:151], v[252:253], v[104:107]
    v_mfma_f32_16x16x16_bf16 v[108:111], v[152:153], v[252:253], v[108:111]
    v_mfma_f32_16x16x16_bf16 v[112:115], v[154:155], v[252:253], v[112:115]
    v_mfma_f32_16x16x16_bf16 v[116:119], v[156:157], v[252:253], v[116:119]
    v_mfma_f32_16x16x16_bf16 v[120:123], v[158:159], v[252:253], v[120:123]
    v_mfma_f32_16x16x16_bf16 v[124:127], v[160:161], v[252:253], v[124:127]
    v_mfma_f32_16x16x16_bf16 v[128:131], v[162:163], v[252:253], v[128:131]
    s_mul_i32 s29, s6, 48
    s_lshl_b32 s30, s8, 1
    s_add_u32 s30, s30, s25
    s_mul_i32 s30, s30, 3
    s_add_u32 s29, s29, s30
    s_add_u32 s29, s29, s28
    s_lshl_b32 s29, s29, 7
    s_lshl_b32 s30, s7, 3
    s_add_u32 s29, s29, s30
    s_lshl_b32 s29, s29, 10
    s_add_u32 s20, s20, s29
    s_addc_u32 s21, s21, 0
    v_lshlrev_b32 v2, 4, v1
    v_add_u32 v9, 4096, v2
    s_nop 7
    v_cvt_pk_bf16_f32 v204, v68, v69
    v_cvt_pk_bf16_f32 v205, v70, v71
    v_cvt_pk_bf16_f32 v206, v72, v73
    v_cvt_pk_bf16_f32 v207, v74, v75
    global_store_dwordx4 v2, v[204:207], s[20:21] offset:0 sc1
    v_cvt_pk_bf16_f32 v208, v76, v77
    v_cvt_pk_bf16_f32 v209, v78, v79
    v_cvt_pk_bf16_f32 v210, v80, v81
    v_cvt_pk_bf16_f32 v211, v82, v83
    global_store_dwordx4 v2, v[208:211], s[20:21] offset:1024 sc1
    v_cvt_pk_bf16_f32 v212, v84, v85
    v_cvt_pk_bf16_f32 v213, v86, v87
    v_cvt_pk_bf16_f32 v214, v88, v89
    v_cvt_pk_bf16_f32 v215, v90, v91
    global_store_dwordx4 v2, v[212:215], s[20:21] offset:2048 sc1
    v_cvt_pk_bf16_f32 v216, v92, v93
    v_cvt_pk_bf16_f32 v217, v94, v95
    v_cvt_pk_bf16_f32 v218, v96, v97
    v_cvt_pk_bf16_f32 v219, v98, v99
    global_store_dwordx4 v2, v[216:219], s[20:21] offset:3072 sc1
    v_cvt_pk_bf16_f32 v204, v100, v101
    v_cvt_pk_bf16_f32 v205, v102, v103
    v_cvt_pk_bf16_f32 v206, v104, v105
    v_cvt_pk_bf16_f32 v207, v106, v107
    global_store_dwordx4 v9, v[204:207], s[20:21] offset:0 sc1
    v_cvt_pk_bf16_f32 v208, v108, v109
    v_cvt_pk_bf16_f32 v209, v110, v111
    v_cvt_pk_bf16_f32 v210, v112, v113
    v_cvt_pk_bf16_f32 v211, v114, v115
    global_store_dwordx4 v9, v[208:211], s[20:21] offset:1024 sc1
    v_cvt_pk_bf16_f32 v212, v116, v117
    v_cvt_pk_bf16_f32 v213, v118, v119
    v_cvt_pk_bf16_f32 v214, v120, v121
    v_cvt_pk_bf16_f32 v215, v122, v123
    global_store_dwordx4 v9, v[212:215], s[20:21] offset:2048 sc1
    v_cvt_pk_bf16_f32 v216, v124, v125
    v_cvt_pk_bf16_f32 v217, v126, v127
    v_cvt_pk_bf16_f32 v218, v128, v129
    v_cvt_pk_bf16_f32 v219, v130, v131
    global_store_dwordx4 v9, v[216:219], s[20:21] offset:3072 sc1
k1_end:
    s_endpgm
k1_pf:
    s_endpgm
.globl k2_kernel
.p2align 8
.type k2_kernel,@function
k2_kernel:
    s_cmp_ge_u32 s2, 256
    s_cbranch_scc1 k2_end
    s_and_b32 s3, s2, 7
    s_lshr_b32 s4, s2, 3
    s_lshr_b32 s6, s3, 2
    s_and_b32 s5, s3, 3
    s_lshl_b32 s5, s5, 1
    s_bfe_u32 s7, s4, 0x10003
    s_add_u32 s7, s7, s5
    s_lshr_b32 s8, s4, 4
    s_and_b32 s9, s4, 7
    s_mul_i32 s10, s6, 40
    s_add_u32 s10, s0, s10
    s_addc_u32 s11, s1, 0
    s_load_dwordx2 s[12:13], s[10:11], 32
    s_load_dwordx2 s[16:17], s[0:1], 96
    v_and_b32 v1, 63, v0
    v_lshrrev_b32 v2, 6, v0
    s_nop 0
    v_readfirstlane_b32 s24, v2
    s_mov_b32 s18, 2341
    v_mul_lo_u32 v3, v0, s18
    v_lshrrev_b32 v3, 16, v3
    v_mul_u32_u24 v4, 28, v3
    v_sub_u32 v4, v0, v4
    v_lshlrev_b32 v4, 4, v4
    v_mul_u32_u24 v5, 896, v3
    v_add_u32 v10, v5, v4
    v_add_u32 v11, 14336, v10
    s_min_u32 s25, s24, 5
    v_lshlrev_b32 v13, 4, v1
    v_lshlrev_b32 v16, 4, v1
    v_and_b32 v3, 15, v1
    v_lshrrev_b32 v4, 4, v1
    v_lshrrev_b32 v5, 2, v3
    v_lshl_add_u32 v5, v4, 2, v5
    v_mul_u32_u24 v5, 448, v5
    v_and_b32 v6, 3, v1
    v_lshlrev_b32 v6, 3, v6
    s_lshl_b32 s18, s24, 6
    s_add_u32 s18, s18, 6144
    v_add3_u32 v18, v5, v6, s18
    v_add_u32 v2, 61440, v16
    v_add_u32 v3, 61440, v18
    s_lshl_b32 s30, s25, 10
    s_lshl_b32 s31, s24, 10
    s_add_u32 s31, s31, 6144
    s_add_u32 s32, s31, 7168
    s_waitcnt lgkmcnt(0)
    s_mul_i32 s18, s7, 458752
    s_mul_i32 s19, s8, 448
    s_add_u32 s18, s18, s19
    s_add_u32 s12, s12, s18
    s_addc_u32 s13, s13, 0
    s_mul_i32 s18, s6, 48
    s_mul_i32 s19, s9, 6
    s_add_u32 s18, s18, s19
    s_add_u32 s18, s18, s25
    s_lshl_b32 s18, s18, 7
    s_lshl_b32 s19, s7, 4
    s_add_u32 s18, s18, s19
    s_lshl_b32 s18, s18, 10
    s_add_u32 s14, s16, s18
    s_addc_u32 s15, s17, 0
    s_lshl_b32 s18, s7, 1
    s_add_u32 s18, s18, s6
    s_lshl_b32 s18, s18, 3
    s_add_u32 s18, s18, s9
    s_lshl_b32 s18, s18, 1
    s_add_u32 s18, s18, s8
    s_mul_i32 s18, s18, 84
    s_mul_i32 s19, s24, 12
    s_add_u32 s18, s18, s19
    s_lshl_b32 s18, s18, 10
    s_add_u32 s18, s18, 16777216
    s_add_u32 s20, s16, s18
    s_addc_u32 s21, s17, 0
    s_add_u32 m0, s31, 0
    s_nop 0
    global_load_lds_dwordx4 v10, s[12:13]
    s_add_u32 m0, s32, 0
    s_nop 0
    global_load_lds_dwordx4 v11, s[12:13]
    s_add_u32 m0, s30, 0
    s_add_u32 s12, s12, 28672
    s_addc_u32 s13, s13, 0
    global_load_lds_dwordx4 v13, s[14:15]
    v_add_u32 v13, 1024, v13
    s_add_u32 m0, s31, 20480
    s_nop 0
    global_load_lds_dwordx4 v10, s[12:13]
    s_add_u32 m0, s32, 20480
    s_nop 0
    global_load_lds_dwordx4 v11, s[12:13]
    s_add_u32 m0, s30, 20480
    s_add_u32 s12, s12, 28672
    s_addc_u32 s13, s13, 0
    global_load_lds_dwordx4 v13, s[14:15]
    v_add_u32 v13, 1024, v13
    s_add_u32 m0, s31, 40960
    s_nop 0
    global_load_lds_dwordx4 v10, s[12:13]
    s_add_u32 m0, s32, 40960
    s_nop 0
    global_load_lds_dwordx4 v11, s[12:13]
    s_add_u32 m0, s30, 40960
    s_add_u32 s12, s12, 28672
    s_addc_u32 s13, s13, 0
    global_load_lds_dwordx4 v13, s[14:15]
    v_add_u32 v13, 1024, v13
    s_add_u32 m0, s31, 61440
    s_nop 0
    global_load_lds_dwordx4 v10, s[12:13]
    s_add_u32 m0, s32, 61440
    s_nop 0
    global_load_lds_dwordx4 v11, s[12:13]
    s_add_u32 m0, s30, 61440
    s_add_u32 s12, s12, 28672
    s_addc_u32 s13, s13, 0
    global_load_lds_dwordx4 v13, s[14:15]
    v_add_u32 v13, 1024, v13
    s_add_u32 m0, s31, 81920
    s_nop 0
    global_load_lds_dwordx4 v10, s[12:13]
    s_add_u32 m0, s32, 81920
    s_nop 0
    global_load_lds_dwordx4 v11, s[12:13]
    s_add_u32 m0, s30, 81920
    s_add_u32 s12, s12, 28672
    s_addc_u32 s13, s13, 0
    global_load_lds_dwordx4 v13, s[14:15]
    v_add_u32 v13, 1024, v13
    s_add_u32 m0, s31, 102400
    s_nop 0
    global_load_lds_dwordx4 v10, s[12:13]
    s_add_u32 m0, s32, 102400
    s_nop 0
    global_load_lds_dwordx4 v11, s[12:13]
    s_add_u32 m0, s30, 102400
    s_add_u32 s12, s12, 28672
    s_addc_u32 s13, s13, 0
    global_load_lds_dwordx4 v13, s[14:15]
    v_add_u32 v13, 1024, v13
    v_mov_b32 v20, 0
    v_mov_b32 v21, 0
    v_mov_b32 v22, 0
    v_mov_b32 v23, 0
    v_mov_b32 v24, 0
    v_mov_b32 v25, 0
    v_mov_b32 v26, 0
    v_mov_b32 v27, 0
    v_mov_b32 v28, 0
    v_mov_b32 v29, 0
    v_mov_b32 v30, 0
    v_mov_b32 v31, 0
    v_mov_b32 v32, 0
    v_mov_b32 v33, 0
    v_mov_b32 v34, 0
    v_mov_b32 v35, 0
    v_mov_b32 v36, 0
    v_mov_b32 v37, 0
    v_mov_b32 v38, 0
    v_mov_b32 v39, 0
    v_mov_b32 v40, 0
    v_mov_b32 v41, 0
    v_mov_b32 v42, 0
    v_mov_b32 v43, 0
    v_mov_b32 v44, 0
    v_mov_b32 v45, 0
    v_mov_b32 v46, 0
    v_mov_b32 v47, 0
    v_mov_b32 v48, 0
    v_mov_b32 v49, 0
    v_mov_b32 v50, 0
    v_mov_b32 v51, 0
    v_mov_b32 v52, 0
    v_mov_b32 v53, 0
    v_mov_b32 v54, 0
    v_mov_b32 v55, 0
    v_mov_b32 v56, 0
    v_mov_b32 v57, 0
    v_mov_b32 v58, 0
    v_mov_b32 v59, 0
    v_mov_b32 v60, 0
    v_mov_b32 v61, 0
    v_mov_b32 v62, 0
    v_mov_b32 v63, 0
    v_mov_b32 v64, 0
    v_mov_b32 v65, 0
    v_mov_b32 v66, 0
    v_mov_b32 v67, 0
    s_waitcnt vmcnt(12)
    s_barrier
    ds_read_b128 v[68:71], v16 offset:0
    ds_read_b128 v[72:75], v16 offset:1024
    ds_read_b128 v[76:79], v16 offset:2048
    ds_read_b128 v[80:83], v16 offset:3072
    ds_read_b128 v[84:87], v16 offset:4096
    ds_read_b128 v[88:91], v16 offset:5120
    ds_read_b64_tr_b16 v[116:117], v18 offset:0
    ds_read_b64_tr_b16 v[118:119], v18 offset:7168
    ds_read_b64_tr_b16 v[120:121], v18 offset:32
    ds_read_b64_tr_b16 v[122:123], v18 offset:7200
    s_waitcnt lgkmcnt(0)
    s_barrier
    s_add_u32 m0, s31, 0
    s_nop 0
    global_load_lds_dwordx4 v10, s[12:13]
    s_add_u32 m0, s32, 0
    s_nop 0
    global_load_lds_dwordx4 v11, s[12:13]
    s_add_u32 m0, s30, 0
    s_add_u32 s12, s12, 28672
    s_addc_u32 s13, s13, 0
    global_load_lds_dwordx4 v13, s[14:15]
    v_add_u32 v13, 1024, v13
    v_mfma_f32_16x16x32_bf16 v[20:23], v[116:119], v[68:71], v[20:23]
    ds_read_b128 v[92:95], v16 offset:20480
    v_mfma_f32_16x16x32_bf16 v[24:27], v[116:119], v[72:75], v[24:27]
    ds_read_b128 v[96:99], v16 offset:21504
    v_mfma_f32_16x16x32_bf16 v[28:31], v[116:119], v[76:79], v[28:31]
    ds_read_b128 v[100:103], v16 offset:22528
    v_mfma_f32_16x16x32_bf16 v[32:35], v[116:119], v[80:83], v[32:35]
    ds_read_b128 v[104:107], v16 offset:23552
    v_mfma_f32_16x16x32_bf16 v[36:39], v[116:119], v[84:87], v[36:39]
    ds_read_b128 v[108:111], v16 offset:24576
    v_mfma_f32_16x16x32_bf16 v[40:43], v[116:119], v[88:91], v[40:43]
    ds_read_b128 v[112:115], v16 offset:25600
    v_mfma_f32_16x16x32_bf16 v[44:47], v[120:123], v[68:71], v[44:47]
    ds_read_b64_tr_b16 v[124:125], v18 offset:20480
    v_mfma_f32_16x16x32_bf16 v[48:51], v[120:123], v[72:75], v[48:51]
    ds_read_b64_tr_b16 v[126:127], v18 offset:27648
    v_mfma_f32_16x16x32_bf16 v[52:55], v[120:123], v[76:79], v[52:55]
    ds_read_b64_tr_b16 v[128:129], v18 offset:20512
    v_mfma_f32_16x16x32_bf16 v[56:59], v[120:123], v[80:83], v[56:59]
    ds_read_b64_tr_b16 v[130:131], v18 offset:27680
    v_mfma_f32_16x16x32_bf16 v[60:63], v[120:123], v[84:87], v[60:63]
    v_mfma_f32_16x16x32_bf16 v[64:67], v[120:123], v[88:91], v[64:67]
    s_waitcnt vmcnt(12) lgkmcnt(0)
    s_barrier
    s_add_u32 m0, s31, 20480
    s_nop 0
    global_load_lds_dwordx4 v10, s[12:13]
    s_add_u32 m0, s32, 20480
    s_nop 0
    global_load_lds_dwordx4 v11, s[12:13]
    s_add_u32 m0, s30, 20480
    s_add_u32 s12, s12, 28672
    s_addc_u32 s13, s13, 0
    global_load_lds_dwordx4 v13, s[14:15]
    v_add_u32 v13, 1024, v13
    v_mfma_f32_16x16x32_bf16 v[20:23], v[124:127], v[92:95], v[20:23]
    ds_read_b128 v[68:71], v16 offset:40960
    v_mfma_f32_16x16x32_bf16 v[24:27], v[124:127], v[96:99], v[24:27]
    ds_read_b128 v[72:75], v16 offset:41984
    v_mfma_f32_16x16x32_bf16 v[28:31], v[124:127], v[100:103], v[28:31]
    ds_read_b128 v[76:79], v16 offset:43008
    v_mfma_f32_16x16x32_bf16 v[32:35], v[124:127], v[104:107], v[32:35]
    ds_read_b128 v[80:83], v16 offset:44032
    v_mfma_f32_16x16x32_bf16 v[36:39], v[124:127], v[108:111], v[36:39]
    ds_read_b128 v[84:87], v16 offset:45056
    v_mfma_f32_16x16x32_bf16 v[40:43], v[124:127], v[112:115], v[40:43]
    ds_read_b128 v[88:91], v16 offset:46080
    v_mfma_f32_16x16x32_bf16 v[44:47], v[128:131], v[92:95], v[44:47]
    ds_read_b64_tr_b16 v[116:117], v18 offset:40960
    v_mfma_f32_16x16x32_bf16 v[48:51], v[128:131], v[96:99], v[48:51]
    ds_read_b64_tr_b16 v[118:119], v18 offset:48128
    v_mfma_f32_16x16x32_bf16 v[52:55], v[128:131], v[100:103], v[52:55]
    ds_read_b64_tr_b16 v[120:121], v18 offset:40992
    v_mfma_f32_16x16x32_bf16 v[56:59], v[128:131], v[104:107], v[56:59]
    ds_read_b64_tr_b16 v[122:123], v18 offset:48160
    v_mfma_f32_16x16x32_bf16 v[60:63], v[128:131], v[108:111], v[60:63]
    v_mfma_f32_16x16x32_bf16 v[64:67], v[128:131], v[112:115], v[64:67]
    s_waitcnt vmcnt(12) lgkmcnt(0)
    s_barrier
    s_add_u32 m0, s31, 40960
    s_nop 0
    global_load_lds_dwordx4 v10, s[12:13]
    s_add_u32 m0, s32, 40960
    s_nop 0
    global_load_lds_dwordx4 v11, s[12:13]
    s_add_u32 m0, s30, 40960
    s_add_u32 s12, s12, 28672
    s_addc_u32 s13, s13, 0
    global_load_lds_dwordx4 v13, s[14:15]
    v_add_u32 v13, 1024, v13
    v_mfma_f32_16x16x32_bf16 v[20:23], v[116:119], v[68:71], v[20:23]
    ds_read_b128 v[92:95], v2 offset:0
    v_mfma_f32_16x16x32_bf16 v[24:27], v[116:119], v[72:75], v[24:27]
    ds_read_b128 v[96:99], v2 offset:1024
    v_mfma_f32_16x16x32_bf16 v[28:31], v[116:119], v[76:79], v[28:31]
    ds_read_b128 v[100:103], v2 offset:2048
    v_mfma_f32_16x16x32_bf16 v[32:35], v[116:119], v[80:83], v[32:35]
    ds_read_b128 v[104:107], v2 offset:3072
    v_mfma_f32_16x16x32_bf16 v[36:39], v[116:119], v[84:87], v[36:39]
    ds_read_b128 v[108:111], v2 offset:4096
    v_mfma_f32_16x16x32_bf16 v[40:43], v[116:119], v[88:91], v[40:43]
    ds_read_b128 v[112:115], v2 offset:5120
    v_mfma_f32_16x16x32_bf16 v[44:47], v[120:123], v[68:71], v[44:47]
    ds_read_b64_tr_b16 v[124:125], v3 offset:0
    v_mfma_f32_16x16x32_bf16 v[48:51], v[120:123], v[72:75], v[48:51]
    ds_read_b64_tr_b16 v[126:127], v3 offset:7168
    v_mfma_f32_16x16x32_bf16 v[52:55], v[120:123], v[76:79], v[52:55]
    ds_read_b64_tr_b16 v[128:129], v3 offset:32
    v_mfma_f32_16x16x32_bf16 v[56:59], v[120:123], v[80:83], v[56:59]
    ds_read_b64_tr_b16 v[130:131], v3 offset:7200
    v_mfma_f32_16x16x32_bf16 v[60:63], v[120:123], v[84:87], v[60:63]
    v_mfma_f32_16x16x32_bf16 v[64:67], v[120:123], v[88:91], v[64:67]
    s_waitcnt vmcnt(12) lgkmcnt(0)
    s_barrier
    s_add_u32 m0, s31, 61440
    s_nop 0
    global_load_lds_dwordx4 v10, s[12:13]
    s_add_u32 m0, s32, 61440
    s_nop 0
    global_load_lds_dwordx4 v11, s[12:13]
    s_add_u32 m0, s30, 61440
    s_add_u32 s12, s12, 28672
    s_addc_u32 s13, s13, 0
    global_load_lds_dwordx4 v13, s[14:15]
    v_add_u32 v13, 1024, v13
    v_mfma_f32_16x16x32_bf16 v[20:23], v[124:127], v[92:95], v[20:23]
    ds_read_b128 v[68:71], v2 offset:20480
    v_mfma_f32_16x16x32_bf16 v[24:27], v[124:127], v[96:99], v[24:27]
    ds_read_b128 v[72:75], v2 offset:21504
    v_mfma_f32_16x16x32_bf16 v[28:31], v[124:127], v[100:103], v[28:31]
    ds_read_b128 v[76:79], v2 offset:22528
    v_mfma_f32_16x16x32_bf16 v[32:35], v[124:127], v[104:107], v[32:35]
    ds_read_b128 v[80:83], v2 offset:23552
    v_mfma_f32_16x16x32_bf16 v[36:39], v[124:127], v[108:111], v[36:39]
    ds_read_b128 v[84:87], v2 offset:24576
    v_mfma_f32_16x16x32_bf16 v[40:43], v[124:127], v[112:115], v[40:43]
    ds_read_b128 v[88:91], v2 offset:25600
    v_mfma_f32_16x16x32_bf16 v[44:47], v[128:131], v[92:95], v[44:47]
    ds_read_b64_tr_b16 v[116:117], v3 offset:20480
    v_mfma_f32_16x16x32_bf16 v[48:51], v[128:131], v[96:99], v[48:51]
    ds_read_b64_tr_b16 v[118:119], v3 offset:27648
    v_mfma_f32_16x16x32_bf16 v[52:55], v[128:131], v[100:103], v[52:55]
    ds_read_b64_tr_b16 v[120:121], v3 offset:20512
    v_mfma_f32_16x16x32_bf16 v[56:59], v[128:131], v[104:107], v[56:59]
    ds_read_b64_tr_b16 v[122:123], v3 offset:27680
    v_mfma_f32_16x16x32_bf16 v[60:63], v[128:131], v[108:111], v[60:63]
    v_mfma_f32_16x16x32_bf16 v[64:67], v[128:131], v[112:115], v[64:67]
    s_waitcnt vmcnt(12) lgkmcnt(0)
    s_barrier
    s_add_u32 m0, s31, 81920
    s_nop 0
    global_load_lds_dwordx4 v10, s[12:13]
    s_add_u32 m0, s32, 81920
    s_nop 0
    global_load_lds_dwordx4 v11, s[12:13]
    s_add_u32 m0, s30, 81920
    s_add_u32 s12, s12, 28672
    s_addc_u32 s13, s13, 0
    global_load_lds_dwordx4 v13, s[14:15]
    v_add_u32 v13, 1024, v13
    v_mfma_f32_16x16x32_bf16 v[20:23], v[116:119], v[68:71], v[20:23]
    ds_read_b128 v[92:95], v2 offset:40960
    v_mfma_f32_16x16x32_bf16 v[24:27], v[116:119], v[72:75], v[24:27]
    ds_read_b128 v[96:99], v2 offset:41984
    v_mfma_f32_16x16x32_bf16 v[28:31], v[116:119], v[76:79], v[28:31]
    ds_read_b128 v[100:103], v2 offset:43008
    v_mfma_f32_16x16x32_bf16 v[32:35], v[116:119], v[80:83], v[32:35]
    ds_read_b128 v[104:107], v2 offset:44032
    v_mfma_f32_16x16x32_bf16 v[36:39], v[116:119], v[84:87], v[36:39]
    ds_read_b128 v[108:111], v2 offset:45056
    v_mfma_f32_16x16x32_bf16 v[40:43], v[116:119], v[88:91], v[40:43]
    ds_read_b128 v[112:115], v2 offset:46080
    v_mfma_f32_16x16x32_bf16 v[44:47], v[120:123], v[68:71], v[44:47]
    ds_read_b64_tr_b16 v[124:125], v3 offset:40960
    v_mfma_f32_16x16x32_bf16 v[48:51], v[120:123], v[72:75], v[48:51]
    ds_read_b64_tr_b16 v[126:127], v3 offset:48128
    v_mfma_f32_16x16x32_bf16 v[52:55], v[120:123], v[76:79], v[52:55]
    ds_read_b64_tr_b16 v[128:129], v3 offset:40992
    v_mfma_f32_16x16x32_bf16 v[56:59], v[120:123], v[80:83], v[56:59]
    ds_read_b64_tr_b16 v[130:131], v3 offset:48160
    v_mfma_f32_16x16x32_bf16 v[60:63], v[120:123], v[84:87], v[60:63]
    v_mfma_f32_16x16x32_bf16 v[64:67], v[120:123], v[88:91], v[64:67]
    s_waitcnt vmcnt(12) lgkmcnt(0)
    s_barrier
    s_add_u32 m0, s31, 102400
    s_nop 0
    global_load_lds_dwordx4 v10, s[12:13]
    s_add_u32 m0, s32, 102400
    s_nop 0
    global_load_lds_dwordx4 v11, s[12:13]
    s_add_u32 m0, s30, 102400
    s_add_u32 s12, s12, 28672
    s_addc_u32 s13, s13, 0
    global_load_lds_dwordx4 v13, s[14:15]
    v_add_u32 v13, 1024, v13
    v_mfma_f32_16x16x32_bf16 v[20:23], v[124:127], v[92:95], v[20:23]
    ds_read_b128 v[68:71], v16 offset:0
    v_mfma_f32_16x16x32_bf16 v[24:27], v[124:127], v[96:99], v[24:27]
    ds_read_b128 v[72:75], v16 offset:1024
    v_mfma_f32_16x16x32_bf16 v[28:31], v[124:127], v[100:103], v[28:31]
    ds_read_b128 v[76:79], v16 offset:2048
    v_mfma_f32_16x16x32_bf16 v[32:35], v[124:127], v[104:107], v[32:35]
    ds_read_b128 v[80:83], v16 offset:3072
    v_mfma_f32_16x16x32_bf16 v[36:39], v[124:127], v[108:111], v[36:39]
    ds_read_b128 v[84:87], v16 offset:4096
    v_mfma_f32_16x16x32_bf16 v[40:43], v[124:127], v[112:115], v[40:43]
    ds_read_b128 v[88:91], v16 offset:5120
    v_mfma_f32_16x16x32_bf16 v[44:47], v[128:131], v[92:95], v[44:47]
    ds_read_b64_tr_b16 v[116:117], v18 offset:0
    v_mfma_f32_16x16x32_bf16 v[48:51], v[128:131], v[96:99], v[48:51]
    ds_read_b64_tr_b16 v[118:119], v18 offset:7168
    v_mfma_f32_16x16x32_bf16 v[52:55], v[128:131], v[100:103], v[52:55]
    ds_read_b64_tr_b16 v[120:121], v18 offset:32
    v_mfma_f32_16x16x32_bf16 v[56:59], v[128:131], v[104:107], v[56:59]
    ds_read_b64_tr_b16 v[122:123], v18 offset:7200
    v_mfma_f32_16x16x32_bf16 v[60:63], v[128:131], v[108:111], v[60:63]
    v_mfma_f32_16x16x32_bf16 v[64:67], v[128:131], v[112:115], v[64:67]
    s_waitcnt vmcnt(12) lgkmcnt(0)
    s_barrier
    s_add_u32 m0, s31, 0
    s_nop 0
    global_load_lds_dwordx4 v10, s[12:13]
    s_add_u32 m0, s32, 0
    s_nop 0
    global_load_lds_dwordx4 v11, s[12:13]
    s_add_u32 m0, s30, 0
    s_add_u32 s12, s12, 28672
    s_addc_u32 s13, s13, 0
    global_load_lds_dwordx4 v13, s[14:15]
    v_add_u32 v13, 1024, v13
    v_mfma_f32_16x16x32_bf16 v[20:23], v[116:119], v[68:71], v[20:23]
    ds_read_b128 v[92:95], v16 offset:20480
    v_mfma_f32_16x16x32_bf16 v[24:27], v[116:119], v[72:75], v[24:27]
    ds_read_b128 v[96:99], v16 offset:21504
    v_mfma_f32_16x16x32_bf16 v[28:31], v[116:119], v[76:79], v[28:31]
    ds_read_b128 v[100:103], v16 offset:22528
    v_mfma_f32_16x16x32_bf16 v[32:35], v[116:119], v[80:83], v[32:35]
    ds_read_b128 v[104:107], v16 offset:23552
    v_mfma_f32_16x16x32_bf16 v[36:39], v[116:119], v[84:87], v[36:39]
    ds_read_b128 v[108:111], v16 offset:24576
    v_mfma_f32_16x16x32_bf16 v[40:43], v[116:119], v[88:91], v[40:43]
    ds_read_b128 v[112:115], v16 offset:25600
    v_mfma_f32_16x16x32_bf16 v[44:47], v[120:123], v[68:71], v[44:47]
    ds_read_b64_tr_b16 v[124:125], v18 offset:20480
    v_mfma_f32_16x16x32_bf16 v[48:51], v[120:123], v[72:75], v[48:51]
    ds_read_b64_tr_b16 v[126:127], v18 offset:27648
    v_mfma_f32_16x16x32_bf16 v[52:55], v[120:123], v[76:79], v[52:55]
    ds_read_b64_tr_b16 v[128:129], v18 offset:20512
    v_mfma_f32_16x16x32_bf16 v[56:59], v[120:123], v[80:83], v[56:59]
    ds_read_b64_tr_b16 v[130:131], v18 offset:27680
    v_mfma_f32_16x16x32_bf16 v[60:63], v[120:123], v[84:87], v[60:63]
    v_mfma_f32_16x16x32_bf16 v[64:67], v[120:123], v[88:91], v[64:67]
    s_waitcnt vmcnt(12) lgkmcnt(0)
    s_barrier
    s_add_u32 m0, s31, 20480
    s_nop 0
    global_load_lds_dwordx4 v10, s[12:13]
    s_add_u32 m0, s32, 20480
    s_nop 0
    global_load_lds_dwordx4 v11, s[12:13]
    s_add_u32 m0, s30, 20480
    s_add_u32 s12, s12, 28672
    s_addc_u32 s13, s13, 0
    global_load_lds_dwordx4 v13, s[14:15]
    v_add_u32 v13, 1024, v13
    v_mfma_f32_16x16x32_bf16 v[20:23], v[124:127], v[92:95], v[20:23]
    ds_read_b128 v[68:71], v16 offset:40960
    v_mfma_f32_16x16x32_bf16 v[24:27], v[124:127], v[96:99], v[24:27]
    ds_read_b128 v[72:75], v16 offset:41984
    v_mfma_f32_16x16x32_bf16 v[28:31], v[124:127], v[100:103], v[28:31]
    ds_read_b128 v[76:79], v16 offset:43008
    v_mfma_f32_16x16x32_bf16 v[32:35], v[124:127], v[104:107], v[32:35]
    ds_read_b128 v[80:83], v16 offset:44032
    v_mfma_f32_16x16x32_bf16 v[36:39], v[124:127], v[108:111], v[36:39]
    ds_read_b128 v[84:87], v16 offset:45056
    v_mfma_f32_16x16x32_bf16 v[40:43], v[124:127], v[112:115], v[40:43]
    ds_read_b128 v[88:91], v16 offset:46080
    v_mfma_f32_16x16x32_bf16 v[44:47], v[128:131], v[92:95], v[44:47]
    ds_read_b64_tr_b16 v[116:117], v18 offset:40960
    v_mfma_f32_16x16x32_bf16 v[48:51], v[128:131], v[96:99], v[48:51]
    ds_read_b64_tr_b16 v[118:119], v18 offset:48128
    v_mfma_f32_16x16x32_bf16 v[52:55], v[128:131], v[100:103], v[52:55]
    ds_read_b64_tr_b16 v[120:121], v18 offset:40992
    v_mfma_f32_16x16x32_bf16 v[56:59], v[128:131], v[104:107], v[56:59]
    ds_read_b64_tr_b16 v[122:123], v18 offset:48160
    v_mfma_f32_16x16x32_bf16 v[60:63], v[128:131], v[108:111], v[60:63]
    v_mfma_f32_16x16x32_bf16 v[64:67], v[128:131], v[112:115], v[64:67]
    s_waitcnt vmcnt(12) lgkmcnt(0)
    s_barrier
    s_add_u32 m0, s31, 40960
    s_nop 0
    global_load_lds_dwordx4 v10, s[12:13]
    s_add_u32 m0, s32, 40960
    s_nop 0
    global_load_lds_dwordx4 v11, s[12:13]
    s_add_u32 m0, s30, 40960
    s_add_u32 s12, s12, 28672
    s_addc_u32 s13, s13, 0
    global_load_lds_dwordx4 v13, s[14:15]
    v_add_u32 v13, 1024, v13
    v_mfma_f32_16x16x32_bf16 v[20:23], v[116:119], v[68:71], v[20:23]
    ds_read_b128 v[92:95], v2 offset:0
    v_mfma_f32_16x16x32_bf16 v[24:27], v[116:119], v[72:75], v[24:27]
    ds_read_b128 v[96:99], v2 offset:1024
    v_mfma_f32_16x16x32_bf16 v[28:31], v[116:119], v[76:79], v[28:31]
    ds_read_b128 v[100:103], v2 offset:2048
    v_mfma_f32_16x16x32_bf16 v[32:35], v[116:119], v[80:83], v[32:35]
    ds_read_b128 v[104:107], v2 offset:3072
    v_mfma_f32_16x16x32_bf16 v[36:39], v[116:119], v[84:87], v[36:39]
    ds_read_b128 v[108:111], v2 offset:4096
    v_mfma_f32_16x16x32_bf16 v[40:43], v[116:119], v[88:91], v[40:43]
    ds_read_b128 v[112:115], v2 offset:5120
    v_mfma_f32_16x16x32_bf16 v[44:47], v[120:123], v[68:71], v[44:47]
    ds_read_b64_tr_b16 v[124:125], v3 offset:0
    v_mfma_f32_16x16x32_bf16 v[48:51], v[120:123], v[72:75], v[48:51]
    ds_read_b64_tr_b16 v[126:127], v3 offset:7168
    v_mfma_f32_16x16x32_bf16 v[52:55], v[120:123], v[76:79], v[52:55]
    ds_read_b64_tr_b16 v[128:129], v3 offset:32
    v_mfma_f32_16x16x32_bf16 v[56:59], v[120:123], v[80:83], v[56:59]
    ds_read_b64_tr_b16 v[130:131], v3 offset:7200
    v_mfma_f32_16x16x32_bf16 v[60:63], v[120:123], v[84:87], v[60:63]
    v_mfma_f32_16x16x32_bf16 v[64:67], v[120:123], v[88:91], v[64:67]
    s_waitcnt vmcnt(12) lgkmcnt(0)
    s_barrier
    s_add_u32 m0, s31, 61440
    s_nop 0
    global_load_lds_dwordx4 v10, s[12:13]
    s_add_u32 m0, s32, 61440
    s_nop 0
    global_load_lds_dwordx4 v11, s[12:13]
    s_add_u32 m0, s30, 61440
    s_add_u32 s12, s12, 28672
    s_addc_u32 s13, s13, 0
    global_load_lds_dwordx4 v13, s[14:15]
    v_add_u32 v13, 1024, v13
    v_mfma_f32_16x16x32_bf16 v[20:23], v[124:127], v[92:95], v[20:23]
    ds_read_b128 v[68:71], v2 offset:20480
    v_mfma_f32_16x16x32_bf16 v[24:27], v[124:127], v[96:99], v[24:27]
    ds_read_b128 v[72:75], v2 offset:21504
    v_mfma_f32_16x16x32_bf16 v[28:31], v[124:127], v[100:103], v[28:31]
    ds_read_b128 v[76:79], v2 offset:22528
    v_mfma_f32_16x16x32_bf16 v[32:35], v[124:127], v[104:107], v[32:35]
    ds_read_b128 v[80:83], v2 offset:23552
    v_mfma_f32_16x16x32_bf16 v[36:39], v[124:127], v[108:111], v[36:39]
    ds_read_b128 v[84:87], v2 offset:24576
    v_mfma_f32_16x16x32_bf16 v[40:43], v[124:127], v[112:115], v[40:43]
    ds_read_b128 v[88:91], v2 offset:25600
    v_mfma_f32_16x16x32_bf16 v[44:47], v[128:131], v[92:95], v[44:47]
    ds_read_b64_tr_b16 v[116:117], v3 offset:20480
    v_mfma_f32_16x16x32_bf16 v[48:51], v[128:131], v[96:99], v[48:51]
    ds_read_b64_tr_b16 v[118:119], v3 offset:27648
    v_mfma_f32_16x16x32_bf16 v[52:55], v[128:131], v[100:103], v[52:55]
    ds_read_b64_tr_b16 v[120:121], v3 offset:20512
    v_mfma_f32_16x16x32_bf16 v[56:59], v[128:131], v[104:107], v[56:59]
    ds_read_b64_tr_b16 v[122:123], v3 offset:27680
    v_mfma_f32_16x16x32_bf16 v[60:63], v[128:131], v[108:111], v[60:63]
    v_mfma_f32_16x16x32_bf16 v[64:67], v[128:131], v[112:115], v[64:67]
    s_waitcnt vmcnt(12) lgkmcnt(0)
    s_barrier
    v_mfma_f32_16x16x32_bf16 v[20:23], v[116:119], v[68:71], v[20:23]
    ds_read_b128 v[92:95], v2 offset:40960
    v_mfma_f32_16x16x32_bf16 v[24:27], v[116:119], v[72:75], v[24:27]
    ds_read_b128 v[96:99], v2 offset:41984
    v_mfma_f32_16x16x32_bf16 v[28:31], v[116:119], v[76:79], v[28:31]
    ds_read_b128 v[100:103], v2 offset:43008
    v_mfma_f32_16x16x32_bf16 v[32:35], v[116:119], v[80:83], v[32:35]
    ds_read_b128 v[104:107], v2 offset:44032
    v_mfma_f32_16x16x32_bf16 v[36:39], v[116:119], v[84:87], v[36:39]
    ds_read_b128 v[108:111], v2 offset:45056
    v_mfma_f32_16x16x32_bf16 v[40:43], v[116:119], v[88:91], v[40:43]
    ds_read_b128 v[112:115], v2 offset:46080
    v_mfma_f32_16x16x32_bf16 v[44:47], v[120:123], v[68:71], v[44:47]
    ds_read_b64_tr_b16 v[124:125], v3 offset:40960
    v_mfma_f32_16x16x32_bf16 v[48:51], v[120:123], v[72:75], v[48:51]
    ds_read_b64_tr_b16 v[126:127], v3 offset:48128
    v_mfma_f32_16x16x32_bf16 v[52:55], v[120:123], v[76:79], v[52:55]
    ds_read_b64_tr_b16 v[128:129], v3 offset:40992
    v_mfma_f32_16x16x32_bf16 v[56:59], v[120:123], v[80:83], v[56:59]
    ds_read_b64_tr_b16 v[130:131], v3 offset:48160
    v_mfma_f32_16x16x32_bf16 v[60:63], v[120:123], v[84:87], v[60:63]
    v_mfma_f32_16x16x32_bf16 v[64:67], v[120:123], v[88:91], v[64:67]
    s_waitcnt vmcnt(9) lgkmcnt(0)
    s_barrier
    v_mfma_f32_16x16x32_bf16 v[20:23], v[124:127], v[92:95], v[20:23]
    ds_read_b128 v[68:71], v16 offset:0
    v_mfma_f32_16x16x32_bf16 v[24:27], v[124:127], v[96:99], v[24:27]
    ds_read_b128 v[72:75], v16 offset:1024
    v_mfma_f32_16x16x32_bf16 v[28:31], v[124:127], v[100:103], v[28:31]
    ds_read_b128 v[76:79], v16 offset:2048
    v_mfma_f32_16x16x32_bf16 v[32:35], v[124:127], v[104:107], v[32:35]
    ds_read_b128 v[80:83], v16 offset:3072
    v_mfma_f32_16x16x32_bf16 v[36:39], v[124:127], v[108:111], v[36:39]
    ds_read_b128 v[84:87], v16 offset:4096
    v_mfma_f32_16x16x32_bf16 v[40:43], v[124:127], v[112:115], v[40:43]
    ds_read_b128 v[88:91], v16 offset:5120
    v_mfma_f32_16x16x32_bf16 v[44:47], v[128:131], v[92:95], v[44:47]
    ds_read_b64_tr_b16 v[116:117], v18 offset:0
    v_mfma_f32_16x16x32_bf16 v[48:51], v[128:131], v[96:99], v[48:51]
    ds_read_b64_tr_b16 v[118:119], v18 offset:7168
    v_mfma_f32_16x16x32_bf16 v[52:55], v[128:131], v[100:103], v[52:55]
    ds_read_b64_tr_b16 v[120:121], v18 offset:32
    v_mfma_f32_16x16x32_bf16 v[56:59], v[128:131], v[104:107], v[56:59]
    ds_read_b64_tr_b16 v[122:123], v18 offset:7200
    v_mfma_f32_16x16x32_bf16 v[60:63], v[128:131], v[108:111], v[60:63]
    v_mfma_f32_16x16x32_bf16 v[64:67], v[128:131], v[112:115], v[64:67]
    s_waitcnt vmcnt(6) lgkmcnt(0)
    s_barrier
    v_mfma_f32_16x16x32_bf16 v[20:23], v[116:119], v[68:71], v[20:23]
    ds_read_b128 v[92:95], v16 offset:20480
    v_mfma_f32_16x16x32_bf16 v[24:27], v[116:119], v[72:75], v[24:27]
    ds_read_b128 v[96:99], v16 offset:21504
    v_mfma_f32_16x16x32_bf16 v[28:31], v[116:119], v[76:79], v[28:31]
    ds_read_b128 v[100:103], v16 offset:22528
    v_mfma_f32_16x16x32_bf16 v[32:35], v[116:119], v[80:83], v[32:35]
    ds_read_b128 v[104:107], v16 offset:23552
    v_mfma_f32_16x16x32_bf16 v[36:39], v[116:119], v[84:87], v[36:39]
    ds_read_b128 v[108:111], v16 offset:24576
    v_mfma_f32_16x16x32_bf16 v[40:43], v[116:119], v[88:91], v[40:43]
    ds_read_b128 v[112:115], v16 offset:25600
    v_mfma_f32_16x16x32_bf16 v[44:47], v[120:123], v[68:71], v[44:47]
    ds_read_b64_tr_b16 v[124:125], v18 offset:20480
    v_mfma_f32_16x16x32_bf16 v[48:51], v[120:123], v[72:75], v[48:51]
    ds_read_b64_tr_b16 v[126:127], v18 offset:27648
    v_mfma_f32_16x16x32_bf16 v[52:55], v[120:123], v[76:79], v[52:55]
    ds_read_b64_tr_b16 v[128:129], v18 offset:20512
    v_mfma_f32_16x16x32_bf16 v[56:59], v[120:123], v[80:83], v[56:59]
    ds_read_b64_tr_b16 v[130:131], v18 offset:27680
    v_mfma_f32_16x16x32_bf16 v[60:63], v[120:123], v[84:87], v[60:63]
    v_mfma_f32_16x16x32_bf16 v[64:67], v[120:123], v[88:91], v[64:67]
    s_waitcnt vmcnt(3) lgkmcnt(0)
    s_barrier
    v_mfma_f32_16x16x32_bf16 v[20:23], v[124:127], v[92:95], v[20:23]
    ds_read_b128 v[68:71], v16 offset:40960
    v_mfma_f32_16x16x32_bf16 v[24:27], v[124:127], v[96:99], v[24:27]
    ds_read_b128 v[72:75], v16 offset:41984
    v_mfma_f32_16x16x32_bf16 v[28:31], v[124:127], v[100:103], v[28:31]
    ds_read_b128 v[76:79], v16 offset:43008
    v_mfma_f32_16x16x32_bf16 v[32:35], v[124:127], v[104:107], v[32:35]
    ds_read_b128 v[80:83], v16 offset:44032
    v_mfma_f32_16x16x32_bf16 v[36:39], v[124:127], v[108:111], v[36:39]
    ds_read_b128 v[84:87], v16 offset:45056
    v_mfma_f32_16x16x32_bf16 v[40:43], v[124:127], v[112:115], v[40:43]
    ds_read_b128 v[88:91], v16 offset:46080
    v_mfma_f32_16x16x32_bf16 v[44:47], v[128:131], v[92:95], v[44:47]
    ds_read_b64_tr_b16 v[116:117], v18 offset:40960
    v_mfma_f32_16x16x32_bf16 v[48:51], v[128:131], v[96:99], v[48:51]
    ds_read_b64_tr_b16 v[118:119], v18 offset:48128
    v_mfma_f32_16x16x32_bf16 v[52:55], v[128:131], v[100:103], v[52:55]
    ds_read_b64_tr_b16 v[120:121], v18 offset:40992
    v_mfma_f32_16x16x32_bf16 v[56:59], v[128:131], v[104:107], v[56:59]
    ds_read_b64_tr_b16 v[122:123], v18 offset:48160
    v_mfma_f32_16x16x32_bf16 v[60:63], v[128:131], v[108:111], v[60:63]
    v_mfma_f32_16x16x32_bf16 v[64:67], v[128:131], v[112:115], v[64:67]
    s_waitcnt vmcnt(0) lgkmcnt(0)
    s_barrier
    v_mfma_f32_16x16x32_bf16 v[20:23], v[116:119], v[68:71], v[20:23]
    ds_read_b128 v[92:95], v2 offset:0
    v_mfma_f32_16x16x32_bf16 v[24:27], v[116:119], v[72:75], v[24:27]
    ds_read_b128 v[96:99], v2 offset:1024
    v_mfma_f32_16x16x32_bf16 v[28:31], v[116:119], v[76:79], v[28:31]
    ds_read_b128 v[100:103], v2 offset:2048
    v_mfma_f32_16x16x32_bf16 v[32:35], v[116:119], v[80:83], v[32:35]
    ds_read_b128 v[104:107], v2 offset:3072
    v_mfma_f32_16x16x32_bf16 v[36:39], v[116:119], v[84:87], v[36:39]
    ds_read_b128 v[108:111], v2 offset:4096
    v_mfma_f32_16x16x32_bf16 v[40:43], v[116:119], v[88:91], v[40:43]
    ds_read_b128 v[112:115], v2 offset:5120
    v_mfma_f32_16x16x32_bf16 v[44:47], v[120:123], v[68:71], v[44:47]
    ds_read_b64_tr_b16 v[124:125], v3 offset:0
    v_mfma_f32_16x16x32_bf16 v[48:51], v[120:123], v[72:75], v[48:51]
    ds_read_b64_tr_b16 v[126:127], v3 offset:7168
    v_mfma_f32_16x16x32_bf16 v[52:55], v[120:123], v[76:79], v[52:55]
    ds_read_b64_tr_b16 v[128:129], v3 offset:32
    v_mfma_f32_16x16x32_bf16 v[56:59], v[120:123], v[80:83], v[56:59]
    ds_read_b64_tr_b16 v[130:131], v3 offset:7200
    v_mfma_f32_16x16x32_bf16 v[60:63], v[120:123], v[84:87], v[60:63]
    v_mfma_f32_16x16x32_bf16 v[64:67], v[120:123], v[88:91], v[64:67]
    s_waitcnt lgkmcnt(0)
    v_mfma_f32_16x16x32_bf16 v[20:23], v[124:127], v[92:95], v[20:23]
    v_mfma_f32_16x16x32_bf16 v[24:27], v[124:127], v[96:99], v[24:27]
    v_mfma_f32_16x16x32_bf16 v[28:31], v[124:127], v[100:103], v[28:31]
    v_mfma_f32_16x16x32_bf16 v[32:35], v[124:127], v[104:107], v[32:35]
    v_mfma_f32_16x16x32_bf16 v[36:39], v[124:127], v[108:111], v[36:39]
    v_mfma_f32_16x16x32_bf16 v[40:43], v[124:127], v[112:115], v[40:43]
    v_mfma_f32_16x16x32_bf16 v[44:47], v[128:131], v[92:95], v[44:47]
    v_mfma_f32_16x16x32_bf16 v[48:51], v[128:131], v[96:99], v[48:51]
    v_mfma_f32_16x16x32_bf16 v[52:55], v[128:131], v[100:103], v[52:55]
    v_mfma_f32_16x16x32_bf16 v[56:59], v[128:131], v[104:107], v[56:59]
    v_mfma_f32_16x16x32_bf16 v[60:63], v[128:131], v[108:111], v[60:63]
    v_mfma_f32_16x16x32_bf16 v[64:67], v[128:131], v[112:115], v[64:67]
    v_lshlrev_b32 v2, 4, v1
    v_add_u32 v3, 4096, v2
    v_add_u32 v4, 8192, v2
    s_nop 7
    global_store_dwordx4 v2, v[20:23], s[20:21] offset:0 sc1
    global_store_dwordx4 v2, v[24:27], s[20:21] offset:1024 sc1
    global_store_dwordx4 v2, v[28:31], s[20:21] offset:2048 sc1
    global_store_dwordx4 v2, v[32:35], s[20:21] offset:3072 sc1
    global_store_dwordx4 v3, v[36:39], s[20:21] offset:0 sc1
    global_store_dwordx4 v3, v[40:43], s[20:21] offset:1024 sc1
    global_store_dwordx4 v3, v[44:47], s[20:21] offset:2048 sc1
    global_store_dwordx4 v3, v[48:51], s[20:21] offset:3072 sc1
    global_store_dwordx4 v4, v[52:55], s[20:21] offset:0 sc1
    global_store_dwordx4 v4, v[56:59], s[20:21] offset:1024 sc1
    global_store_dwordx4 v4, v[60:63], s[20:21] offset:2048 sc1
    global_store_dwordx4 v4, v[64:67], s[20:21] offset:3072 sc1
k2_end:
    s_endpgm
.globl k3_kernel
.p2align 8
.type k3_kernel,@function
k3_kernel:
    s_cmp_ge_u32 s2, 336
    s_cbranch_scc1 k3_end
    s_load_dwordx2 s[14:15], s[0:1], 80
    s_load_dwordx2 s[16:17], s[0:1], 96
    v_and_b32 v1, 63, v0
    v_lshrrev_b32 v2, 6, v0
    s_nop 0
    v_readfirstlane_b32 s24, v2
    s_lshl_b32 s3, s2, 3
    s_add_u32 s3, s3, s24
    s_mul_i32 s4, s3, 3121
    s_lshr_b32 s4, s4, 18
    s_mul_i32 s5, s4, 84
    s_sub_u32 s5, s3, s5
    s_mul_i32 s6, s5, 43
    s_lshr_b32 s6, s6, 8
    s_mul_i32 s7, s6, 6
    s_sub_u32 s7, s5, s7
    s_and_b32 s8, s4, 1
    s_bfe_u32 s9, s4, 0x30001
    s_lshr_b32 s10, s4, 4
    s_mul_i32 s11, s9, 96
    s_lshl_b32 s12, s7, 4
    s_add_u32 s11, s11, s12
    s_mul_i32 s11, s11, 1792
    s_mul_i32 s12, s10, 896
    s_add_u32 s11, s11, s12
    s_mul_i32 s12, s8, 448
    s_add_u32 s11, s11, s12
    s_lshl_b32 s12, s6, 5
    s_add_u32 s11, s11, s12
    s_lshl_b32 s12, s3, 10
    s_add_u32 s12, s12, 16777216
    v_lshlrev_b32 v2, 4, v1
    v_and_b32 v3, 15, v1
    v_lshrrev_b32 v4, 4, v1
    v_mul_u32_u24 v5, 1792, v3
    v_lshl_add_u32 v5, v4, 3, v5
    s_waitcnt lgkmcnt(0)
    s_add_u32 s16, s16, s12
    s_addc_u32 s17, s17, 0
    s_add_u32 s14, s14, s11
    s_addc_u32 s15, s15, 0
    global_load_dwordx4 v[8:11], v2, s[16:17]
    s_add_u32 s16, s16, 2752512
    s_addc_u32 s17, s17, 0
    global_load_dwordx4 v[12:15], v2, s[16:17]
    s_add_u32 s16, s16, 2752512
    s_addc_u32 s17, s17, 0
    global_load_dwordx4 v[16:19], v2, s[16:17]
    s_add_u32 s16, s16, 2752512
    s_addc_u32 s17, s17, 0
    global_load_dwordx4 v[20:23], v2, s[16:17]
    s_add_u32 s16, s16, 2752512
    s_addc_u32 s17, s17, 0
    global_load_dwordx4 v[24:27], v2, s[16:17]
    s_add_u32 s16, s16, 2752512
    s_addc_u32 s17, s17, 0
    global_load_dwordx4 v[28:31], v2, s[16:17]
    s_add_u32 s16, s16, 2752512
    s_addc_u32 s17, s17, 0
    global_load_dwordx4 v[32:35], v2, s[16:17]
    s_add_u32 s16, s16, 2752512
    s_addc_u32 s17, s17, 0
    global_load_dwordx4 v[36:39], v2, s[16:17]
    s_waitcnt vmcnt(6)
    v_add_f32 v8, v8, v12
    v_add_f32 v9, v9, v13
    v_add_f32 v10, v10, v14
    v_add_f32 v11, v11, v15
    s_waitcnt vmcnt(5)
    v_add_f32 v8, v8, v16
    v_add_f32 v9, v9, v17
    v_add_f32 v10, v10, v18
    v_add_f32 v11, v11, v19
    s_waitcnt vmcnt(4)
    v_add_f32 v8, v8, v20
    v_add_f32 v9, v9, v21
    v_add_f32 v10, v10, v22
    v_add_f32 v11, v11, v23
    s_waitcnt vmcnt(3)
    v_add_f32 v8, v8, v24
    v_add_f32 v9, v9, v25
    v_add_f32 v10, v10, v26
    v_add_f32 v11, v11, v27
    s_waitcnt vmcnt(2)
    v_add_f32 v8, v8, v28
    v_add_f32 v9, v9, v29
    v_add_f32 v10, v10, v30
    v_add_f32 v11, v11, v31
    s_waitcnt vmcnt(1)
    v_add_f32 v8, v8, v32
    v_add_f32 v9, v9, v33
    v_add_f32 v10, v10, v34
    v_add_f32 v11, v11, v35
    s_waitcnt vmcnt(0)
    v_add_f32 v8, v8, v36
    v_add_f32 v9, v9, v37
    v_add_f32 v10, v10, v38
    v_add_f32 v11, v11, v39
    v_cvt_pk_bf16_f32 v6, v8, v9
    v_cvt_pk_bf16_f32 v7, v10, v11
    global_store_dwordx2 v5, v[6:7], s[14:15]
k3_end:
    s_endpgm
.section .rodata,"a"
.p2align 6
.amdhsa_kernel k1_kernel
  .amdhsa_next_free_vgpr 256
  .amdhsa_next_free_sgpr 64
  .amdhsa_accum_offset 256
  .amdhsa_group_segment_fixed_size 0
  .amdhsa_kernarg_size 104
  .amdhsa_user_sgpr_count 2
  .amdhsa_user_sgpr_kernarg_segment_ptr 1
  .amdhsa_system_sgpr_workgroup_id_x 1
.end_amdhsa_kernel
.p2align 6
.amdhsa_kernel k2_kernel
  .amdhsa_next_free_vgpr 132
  .amdhsa_next_free_sgpr 64
  .amdhsa_accum_offset 132
  .amdhsa_group_segment_fixed_size 0
  .amdhsa_kernarg_size 104
  .amdhsa_user_sgpr_count 2
  .amdhsa_user_sgpr_kernarg_segment_ptr 1
  .amdhsa_system_sgpr_workgroup_id_x 1
.end_amdhsa_kernel
.p2align 6
.amdhsa_kernel k3_kernel
  .amdhsa_next_free_vgpr 40
  .amdhsa_next_free_sgpr 40
  .amdhsa_accum_offset 40
  .amdhsa_group_segment_fixed_size 0
  .amdhsa_kernarg_size 104
  .amdhsa_user_sgpr_count 2
  .amdhsa_user_sgpr_kernarg_segment_ptr 1
  .amdhsa_system_sgpr_workgroup_id_x 1
.end_amdhsa_kernel
```
